```python
import torch

def _softmax(x, axis=-1):
    return torch.softmax(x, dim=axis)
def _gelu(x):
    return torch.nn.functional.gelu(x, approximate="tanh")
def _silu(x):
    return torch.nn.functional.silu(x)
def _sigmoid(x):
    return torch.sigmoid(x)
def _layernorm(x, axis=-1, eps=1e-5):
    m = x.mean(dim=axis, keepdim=True)
    v = x.var(dim=axis, keepdim=True, unbiased=False)
    return (x - m) / torch.sqrt(v + eps)
def _scatter_add(tgt, idx, src, axis=0):
    return tgt.clone().index_add_(axis, idx, src)
def _segment_sum(src, seg, n):
    out = torch.zeros((n,) + src.shape[1:], dtype=src.dtype)
    return out.index_add_(0, seg, src)
def _pad(x, pw):
    flat = tuple(v for pair in reversed(pw) for v in pair)
    return torch.nn.functional.pad(x, flat)

kernel_name = 'concat_heads__gqa_block_cached__mha_block_cached__near_ridge'

def setup_inputs():

    _w = (lambda a: (lambda t: t.to(torch.bfloat16) if t.is_floating_point() else t)(torch.as_tensor(a)))
    def _A_setup():
        B, Sq, D = 32, 32, 512
        Hq, Hkv, Sk, Dh = 32, 32, 32, 128
        assert Hq % Hkv == 0, (Hq, Hkv)
        return {
            "x": _w((lambda *s: torch.randn(*s, dtype=torch.bfloat16) * 0.8)(B, Sq, D)),
            "k_cache": _w((lambda *s: torch.randn(*s, dtype=torch.bfloat16) * 0.8)(B, Hkv, Sk, Dh)),
            "v_cache": _w((lambda *s: torch.randn(*s, dtype=torch.bfloat16) * 0.05)(B, Hkv, Sk, Dh)),
            "wq": _w((lambda *s: torch.randn(*s, dtype=torch.bfloat16) * 0.8)(D, Hq * Dh) * (D ** -0.5)),
            "wo": _w((lambda *s: torch.randn(*s, dtype=torch.bfloat16) * 0.05)(Hq * Dh, D) * ((Hq * Dh) ** -0.5)),
        }
    _A_in = _A_setup()

    def _B_setup():
        B, Sq, D = 32, 32, 512
        H, Sk, Dh = 32, 32, 128
        return {
            "x": _w((lambda *s: torch.randn(*s, dtype=torch.bfloat16) * 0.8)(B, Sq, D)),
            "k_cache": _w((lambda *s: torch.randn(*s, dtype=torch.bfloat16) * 0.8)(B, H, Sk, Dh)),
            "v_cache": _w((lambda *s: torch.randn(*s, dtype=torch.bfloat16) * 0.05)(B, H, Sk, Dh)),
            "wq": _w((lambda *s: torch.randn(*s, dtype=torch.bfloat16) * 0.8)(D, H * Dh) * (D ** -0.5)),
            "wo": _w((lambda *s: torch.randn(*s, dtype=torch.bfloat16) * 0.05)(H * Dh, D) * ((H * Dh) ** -0.5)),
        }
    _B_in = _B_setup()

    return {
        "A_x": _A_in["x"],
        "A_k_cache": _A_in["k_cache"],
        "A_v_cache": _A_in["v_cache"],
        "A_wq": _A_in["wq"],
        "A_wo": _A_in["wo"],
        "B_x": _B_in["x"],
        "B_k_cache": _B_in["k_cache"],
        "B_v_cache": _B_in["v_cache"],
        "B_wq": _B_in["wq"],
        "B_wo": _B_in["wo"],
    }

def reference(A_x, A_k_cache, A_v_cache, A_wq, A_wo, B_x, B_k_cache, B_v_cache, B_wq, B_wo):
    def _A_ref(x, k_cache, v_cache, wq, wo):
        B, Sq, D = x.shape
        Hq, Dh = 32, 128
        Hkv = k_cache.shape[1]
        rep = Hq // Hkv
        q = (lambda x, *d: x.permute(*d))((x @ wq).reshape(B, Sq, Hq, Dh), 0, 2, 1, 3)
        k = (lambda x, n, axis: torch.repeat_interleave(x, n, dim=axis))(k_cache, rep, axis=1)
        v = (lambda x, n, axis: torch.repeat_interleave(x, n, dim=axis))(v_cache, rep, axis=1)
        scores = torch.einsum("bhqd,bhkd->bhqk", q, k) * (Dh ** -0.5)
        p = _softmax(scores, axis=-1)
        o = torch.einsum("bhqk,bhkd->bhqd", p, v)
        return (lambda x, *d: x.permute(*d))(o, 0, 2, 1, 3).reshape(B, Sq, Hq * Dh) @ wo

    def _B_ref(x, k_cache, v_cache, wq, wo):
        B, Sq, D = x.shape
        H, Dh = 32, 128
        q = (lambda x, *d: x.permute(*d))((x @ wq).reshape(B, Sq, H, Dh), 0, 2, 1, 3)
        scores = torch.einsum("bhqd,bhkd->bhqk", q, k_cache) * (Dh ** -0.5)
        p = _softmax(scores, axis=-1)
        o = torch.einsum("bhqk,bhkd->bhqd", p, v_cache)
        return (lambda x, *d: x.permute(*d))(o, 0, 2, 1, 3).reshape(B, Sq, H * Dh) @ wo

    a = _A_ref(A_x, A_k_cache, A_v_cache, A_wq, A_wo)
    b = _B_ref(B_x, B_k_cache, B_v_cache, B_wq, B_wo)
    return torch.concatenate([a, b], axis=-1)
```

```asm
; @launch grid=(256,1,1) block=(512,1,1) lds=163840
.amdgcn_target "amdgcn-amd-amdhsa--gfx950"
.text
.globl concat_heads__gqa_block_cached__mha_block_cached__near_ridge_kernel
.p2align 8
.type concat_heads__gqa_block_cached__mha_block_cached__near_ridge_kernel,@function
concat_heads__gqa_block_cached__mha_block_cached__near_ridge_kernel:
    s_cmp_ge_u32 s2, 256
    s_cbranch_scc1 F_DONE
    s_load_dwordx16 s[16:31], s[0:1], 0
    s_load_dwordx8 s[32:39], s[0:1], 64
    s_load_dwordx2 s[14:15], s[0:1], 96
    v_lshrrev_b32 v190, 6, v0
    v_and_b32 v200, 63, v0
    s_nop 0
    v_readfirstlane_b32 s60, v190
    s_load_dwordx2 s[10:11], s[0:1], 88
    s_getreg_b32 s12, hwreg(HW_REG_XCC_ID)
    s_and_b32 s12, s12, 7
    s_cmp_lg_u32 s60, 0
    s_cbranch_scc1 F_TK_WAIT
    s_waitcnt lgkmcnt(0)
    s_mov_b32 s4, s10
    s_and_b32 s5, s11, 0xffff
    s_mov_b32 s6, 0x100
    s_mov_b32 s7, 0x00020000
    s_lshl_b32 s13, s12, 2
    v_mov_b32 v191, s13
    v_mov_b32 v192, 1
    v_mov_b32 v193, 0
    v_cmp_eq_u32 vcc, 0, v200
    s_and_saveexec_b64 s[8:9], vcc
    buffer_atomic_add v192, v191, s[4:7], 0 offen sc0
    s_waitcnt vmcnt(0)
    ds_write_b32 v193, v192
    s_mov_b64 exec, s[8:9]
    s_waitcnt lgkmcnt(0)
    s_branch F_TK_JOIN
F_TK_WAIT:
    s_waitcnt lgkmcnt(0)
    s_cmp_lt_u32 s12, 4
    s_cselect_b32 s4, s16, s26
    s_cselect_b32 s5, s17, s27
    s_cselect_b32 s8, s22, s32
    s_cselect_b32 s9, s23, s33
    s_and_b32 s5, s5, 0xffff
    s_mov_b32 s6, 0x100000
    s_mov_b32 s7, 0x00020000
    s_and_b32 s9, s9, 0xffff
    s_mov_b32 s10, 0x400000
    s_mov_b32 s11, 0x00020000
    s_lshr_b32 s13, s2, 3
    v_lshlrev_b32 v191, 4, v200
    s_lshl_b32 s70, s13, 5
    s_lshl_b32 s71, s60, 2
    s_add_u32 s70, s70, s71
    s_lshl_b32 s70, s70, 10
    buffer_load_dwordx4 v[204:207], v191, s[4:7], s70 offen offset:0
    buffer_load_dwordx4 v[208:211], v191, s[4:7], s70 offen offset:1024
    buffer_load_dwordx4 v[204:207], v191, s[4:7], s70 offen offset:2048
    buffer_load_dwordx4 v[208:211], v191, s[4:7], s70 offen offset:3072
    s_lshl_b32 s70, s13, 4
    s_lshl_b32 s71, s60, 1
    s_add_u32 s70, s70, s71
    s_lshl_b32 s70, s70, 13
    s_and_b32 s71, s12, 3
    s_lshl_b32 s71, s71, 11
    s_add_u32 s70, s70, s71
    s_add_u32 s71, s70, 8192
    buffer_load_dwordx4 v[204:207], v191, s[8:11], s70 offen offset:0
    buffer_load_dwordx4 v[208:211], v191, s[8:11], s70 offen offset:1024
    buffer_load_dwordx4 v[204:207], v191, s[8:11], s71 offen offset:0
    buffer_load_dwordx4 v[208:211], v191, s[8:11], s71 offen offset:1024
F_TK_JOIN:
    s_barrier
    v_mov_b32 v193, 0
    ds_read_b32 v192, v193
    s_waitcnt lgkmcnt(0)
    v_readfirstlane_b32 s13, v192
    s_nop 3
    s_barrier
    s_lshr_b32 s3, s13, 5
    s_and_b32 s13, s13, 31
    s_lshl_b32 s13, s13, 3
    s_add_u32 s2, s13, s12
    s_and_b32 s70, s2, 7
    s_lshr_b32 s71, s2, 3
    s_lshr_b32 s63, s71, 2
    s_and_b32 s71, s71, 3
    s_and_b32 s81, s70, 3
    s_lshl_b32 s64, s81, 3
    s_lshl_b32 s72, s71, 1
    s_add_u32 s64, s64, s72
    s_lshr_b32 s80, s70, 2
    s_mov_b32 s13, s71
    v_lshrrev_b32 v190, 2, v200
    v_and_b32 v191, 3, v200
    v_lshrrev_b32 v192, 4, v200
    v_xor_b32 v191, v191, v192
    s_lshl_b32 s70, s63, 7
    s_lshl_b32 s71, s60, 4
    s_add_u32 s70, s70, s71
    v_add_u32 v190, s70, v190
    v_lshlrev_b32 v190, 10, v190
    v_lshl_add_u32 v188, v191, 4, v190
    s_lshl_b32 s74, s60, 10
    v_lshrrev_b32 v190, 4, v200
    v_and_b32 v191, 15, v200
    v_lshlrev_b32 v192, 2, v190
    v_xor_b32 v191, v191, v192
    s_lshr_b32 s70, s60, 1
    s_lshl_b32 s70, s70, 3
    v_add_u32 v190, s70, v190
    v_lshlrev_b32 v190, 13, v190
    v_lshl_add_u32 v190, v191, 4, v190
    s_and_b32 s71, s60, 1
    s_add_u32 s72, s64, s71
    s_lshl_b32 s72, s72, 8
    v_add_u32 v189, s72, v190
    s_lshl_b32 s75, s71, 13
    s_lshl_b32 s70, s70, 8
    s_add_u32 s75, s75, s70
    s_add_u32 s75, s75, 8192
    s_waitcnt lgkmcnt(0)
    s_cmp_eq_u32 s80, 0
    s_cselect_b32 s16, s16, s26
    s_cselect_b32 s17, s17, s27
    s_cselect_b32 s18, s18, s28
    s_cselect_b32 s19, s19, s29
    s_cselect_b32 s20, s20, s30
    s_cselect_b32 s21, s21, s31
    s_cselect_b32 s22, s22, s32
    s_cselect_b32 s23, s23, s33
    s_cselect_b32 s24, s24, s34
    s_cselect_b32 s25, s25, s35
    s_mov_b32 s26, s36
    s_mov_b32 s27, s37
    s_mov_b32 s28, s38
    s_mov_b32 s29, s39
    s_mov_b32 s30, s14
    s_mov_b32 s31, s15
    s_mov_b32 s39, s13
    s_mov_b32 s40, s16
    s_and_b32 s41, s17, 0xffff
    s_mov_b32 s42, 0x100000
    s_mov_b32 s43, 0x00020000
    s_mov_b32 s44, s22
    s_and_b32 s45, s23, 0xffff
    s_mov_b32 s46, 0x400000
    s_mov_b32 s47, 0x00020000
    s_mov_b32 s76, 0
    s_add_u32 m0, s74, 0
    s_nop 0
    buffer_load_dwordx4 v188, s[40:43], s76 offen lds
    s_mov_b32 s77, 0
    s_add_u32 m0, s75, 0
    s_nop 0
    buffer_load_dwordx4 v189, s[44:47], s77 offen lds
    s_mov_b32 s77, 32768
    s_add_u32 m0, s75, 1024
    s_nop 0
    buffer_load_dwordx4 v189, s[44:47], s77 offen lds
    s_mov_b32 s76, 64
    s_add_u32 m0, s74, 24576
    s_nop 0
    buffer_load_dwordx4 v188, s[40:43], s76 offen lds
    s_mov_b32 s77, 262144
    s_add_u32 m0, s75, 24576
    s_nop 0
    buffer_load_dwordx4 v189, s[44:47], s77 offen lds
    s_mov_b32 s77, 294912
    s_add_u32 m0, s75, 25600
    s_nop 0
    buffer_load_dwordx4 v189, s[44:47], s77 offen lds
    s_mov_b32 s76, 128
    s_add_u32 m0, s74, 49152
    s_nop 0
    buffer_load_dwordx4 v188, s[40:43], s76 offen lds
    s_mov_b32 s77, 524288
    s_add_u32 m0, s75, 49152
    s_nop 0
    buffer_load_dwordx4 v189, s[44:47], s77 offen lds
    s_mov_b32 s77, 557056
    s_add_u32 m0, s75, 50176
    s_nop 0
    buffer_load_dwordx4 v189, s[44:47], s77 offen lds
    s_mov_b32 s76, 192
    s_add_u32 m0, s74, 73728
    s_nop 0
    buffer_load_dwordx4 v188, s[40:43], s76 offen lds
    s_mov_b32 s77, 786432
    s_add_u32 m0, s75, 73728
    s_nop 0
    buffer_load_dwordx4 v189, s[44:47], s77 offen lds
    s_mov_b32 s77, 819200
    s_add_u32 m0, s75, 74752
    s_nop 0
    buffer_load_dwordx4 v189, s[44:47], s77 offen lds
    s_mov_b32 s48, s18
    s_and_b32 s49, s19, 0xffff
    s_mov_b32 s50, 0x800000
    s_mov_b32 s51, 0x00020000
    s_mov_b32 s52, s20
    s_and_b32 s53, s21, 0xffff
    s_mov_b32 s54, 0x800000
    s_mov_b32 s55, 0x00020000
    s_lshl_b32 s70, s80, 23
    s_add_u32 s36, s30, s70
    s_addc_u32 s37, s31, 0
    s_mov_b32 s56, s36
    s_and_b32 s57, s37, 0xffff
    s_mov_b32 s58, 0x800000
    s_mov_b32 s59, 0x00020000
    s_lshr_b32 s61, s60, 1
    s_and_b32 s62, s60, 1
    s_lshl_b32 s65, s63, 2
    s_add_u32 s65, s65, s61
    s_add_u32 s66, s64, s62
    s_mov_b32 s78, 0x3db504f3
    s_mov_b32 s79, 0x3fb8aa3b
    v_and_b32 v190, 31, v200
    v_lshrrev_b32 v191, 5, v200
    v_lshlrev_b32 v187, 4, v200
    s_lshl_b32 s67, s65, 5
    s_add_u32 s67, s67, s66
    s_lshl_b32 s67, s67, 13
    s_add_u32 s68, s67, 4096
    v_bfe_u32 v192, v190, 2, 2
    s_lshl_b32 s70, s61, 5
    v_add_u32 v193, s70, v190
    v_lshlrev_b32 v193, 6, v193
    v_add_u32 v194, 0, v191
    v_xor_b32 v194, v194, v192
    v_lshl_add_u32 v168, v194, 4, v193
    v_add_u32 v170, 49152, v168
    v_add_u32 v172, 98304, v168
    v_add_u32 v194, 2, v191
    v_xor_b32 v194, v194, v192
    v_lshl_add_u32 v169, v194, 4, v193
    v_add_u32 v171, 49152, v169
    v_add_u32 v173, 98304, v169
    v_lshrrev_b32 v190, 4, v200
    v_and_b32 v191, 1, v190
    v_lshrrev_b32 v190, 1, v190
    v_bfe_u32 v192, v200, 2, 2
    v_and_b32 v193, 1, v200
    v_bfe_u32 v194, v200, 1, 1
    v_lshl_add_u32 v193, v193, 1, v194
    v_lshlrev_b32 v193, 3, v193
    v_lshl_add_u32 v193, v191, 5, v193
    v_lshl_add_u32 v194, v190, 3, v192
    v_lshl_add_u32 v194, v194, 8, v193
    s_lshl_b32 s70, s62, 13
    s_add_u32 s70, s70, 8192
    v_add_u32 v194, s70, v194
    v_xor_b32 v191, 0, v192
    v_lshl_add_u32 v174, v191, 6, v194
    v_add_u32 v178, 49152, v174
    v_add_u32 v182, 98304, v174
    v_xor_b32 v191, 1, v192
    v_lshl_add_u32 v175, v191, 6, v194
    v_add_u32 v179, 49152, v175
    v_add_u32 v183, 98304, v175
    v_xor_b32 v191, 2, v192
    v_lshl_add_u32 v176, v191, 6, v194
    v_add_u32 v180, 49152, v176
    v_add_u32 v184, 98304, v176
    v_xor_b32 v191, 3, v192
    v_lshl_add_u32 v177, v191, 6, v194
    v_add_u32 v181, 49152, v177
    v_add_u32 v185, 98304, v177
    v_mov_b32 v0, 0
    v_mov_b32 v1, 0
    v_mov_b32 v2, 0
    v_mov_b32 v3, 0
    v_mov_b32 v4, 0
    v_mov_b32 v5, 0
    v_mov_b32 v6, 0
    v_mov_b32 v7, 0
    v_mov_b32 v8, 0
    v_mov_b32 v9, 0
    v_mov_b32 v10, 0
    v_mov_b32 v11, 0
    v_mov_b32 v12, 0
    v_mov_b32 v13, 0
    v_mov_b32 v14, 0
    v_mov_b32 v15, 0
    v_mov_b32 v16, 0
    v_mov_b32 v17, 0
    v_mov_b32 v18, 0
    v_mov_b32 v19, 0
    v_mov_b32 v20, 0
    v_mov_b32 v21, 0
    v_mov_b32 v22, 0
    v_mov_b32 v23, 0
    v_mov_b32 v24, 0
    v_mov_b32 v25, 0
    v_mov_b32 v26, 0
    v_mov_b32 v27, 0
    v_mov_b32 v28, 0
    v_mov_b32 v29, 0
    v_mov_b32 v30, 0
    v_mov_b32 v31, 0
    v_mov_b32 v32, 0
    v_mov_b32 v33, 0
    v_mov_b32 v34, 0
    v_mov_b32 v35, 0
    v_mov_b32 v36, 0
    v_mov_b32 v37, 0
    v_mov_b32 v38, 0
    v_mov_b32 v39, 0
    v_mov_b32 v40, 0
    v_mov_b32 v41, 0
    v_mov_b32 v42, 0
    v_mov_b32 v43, 0
    v_mov_b32 v44, 0
    v_mov_b32 v45, 0
    v_mov_b32 v46, 0
    v_mov_b32 v47, 0
    v_mov_b32 v48, 0
    v_mov_b32 v49, 0
    v_mov_b32 v50, 0
    v_mov_b32 v51, 0
    v_mov_b32 v52, 0
    v_mov_b32 v53, 0
    v_mov_b32 v54, 0
    v_mov_b32 v55, 0
    v_mov_b32 v56, 0
    v_mov_b32 v57, 0
    v_mov_b32 v58, 0
    v_mov_b32 v59, 0
    v_mov_b32 v60, 0
    v_mov_b32 v61, 0
    v_mov_b32 v62, 0
    v_mov_b32 v63, 0
    s_mov_b32 s4, s24
    s_and_b32 s5, s25, 0xffff
    s_mov_b32 s6, 0x400000
    s_mov_b32 s7, 0x00020000
    s_lshr_b32 s70, s2, 3
    s_lshl_b32 s70, s70, 5
    s_lshl_b32 s71, s60, 2
    s_add_u32 s70, s70, s71
    s_lshl_b32 s71, s81, 10
    s_add_u32 s70, s70, s71
    s_lshl_b32 s9, s70, 10
    s_waitcnt vmcnt(9)
    s_barrier
    ds_read_b128 v[160:163], v168 offset:0
    ds_read_b64_tr_b16 v[128:129], v174 offset:0
    ds_read_b64_tr_b16 v[130:131], v174 offset:1024
    ds_read_b64_tr_b16 v[132:133], v175 offset:0
    ds_read_b64_tr_b16 v[134:135], v175 offset:1024
    ds_read_b64_tr_b16 v[136:137], v176 offset:0
    ds_read_b64_tr_b16 v[138:139], v176 offset:1024
    ds_read_b64_tr_b16 v[140:141], v177 offset:0
    ds_read_b64_tr_b16 v[142:143], v177 offset:1024
    s_mov_b32 s76, 256
    s_add_u32 m0, s74, 98304
    s_nop 0
    buffer_load_dwordx4 v188, s[40:43], s76 offen lds
    s_mov_b32 s77, 1048576
    s_add_u32 m0, s75, 98304
    s_nop 0
    buffer_load_dwordx4 v189, s[44:47], s77 offen lds
    s_mov_b32 s77, 1081344
    s_add_u32 m0, s75, 99328
    s_nop 0
    buffer_load_dwordx4 v189, s[44:47], s77 offen lds
    s_mov_b32 s76, 320
    s_add_u32 m0, s74, 122880
    s_nop 0
    buffer_load_dwordx4 v188, s[40:43], s76 offen lds
    s_mov_b32 s77, 1310720
    s_add_u32 m0, s75, 122880
    s_nop 0
    buffer_load_dwordx4 v189, s[44:47], s77 offen lds
    s_mov_b32 s77, 1343488
    s_add_u32 m0, s75, 123904
    s_nop 0
    buffer_load_dwordx4 v189, s[44:47], s77 offen lds
    s_waitcnt lgkmcnt(6)
    ds_read_b128 v[164:167], v169 offset:0
    ds_read_b64_tr_b16 v[144:145], v174 offset:4096
    ds_read_b64_tr_b16 v[146:147], v174 offset:5120
    ds_read_b64_tr_b16 v[148:149], v175 offset:4096
    ds_read_b64_tr_b16 v[150:151], v175 offset:5120
    ds_read_b64_tr_b16 v[152:153], v176 offset:4096
    ds_read_b64_tr_b16 v[154:155], v176 offset:5120
    ds_read_b64_tr_b16 v[156:157], v177 offset:4096
    ds_read_b64_tr_b16 v[158:159], v177 offset:5120
    s_waitcnt lgkmcnt(15)
    v_mfma_f32_32x32x16_bf16 v[0:15], v[128:131], v[160:163], v[0:15]
    buffer_load_dwordx4 v[64:67], v187, s[48:51], s67 offen offset:0 sc0 sc1 nt
    s_waitcnt lgkmcnt(13)
    v_mfma_f32_32x32x16_bf16 v[16:31], v[132:135], v[160:163], v[16:31]
    s_waitcnt lgkmcnt(11)
    v_mfma_f32_32x32x16_bf16 v[32:47], v[136:139], v[160:163], v[32:47]
    s_waitcnt lgkmcnt(9)
    v_mfma_f32_32x32x16_bf16 v[48:63], v[140:143], v[160:163], v[48:63]
    s_waitcnt lgkmcnt(0)
    s_waitcnt vmcnt(13)
    s_barrier
    ds_read_b128 v[160:163], v168 offset:24576
    ds_read_b64_tr_b16 v[128:129], v174 offset:24576
    ds_read_b64_tr_b16 v[130:131], v174 offset:25600
    ds_read_b64_tr_b16 v[132:133], v175 offset:24576
    ds_read_b64_tr_b16 v[134:135], v175 offset:25600
    ds_read_b64_tr_b16 v[136:137], v176 offset:24576
    ds_read_b64_tr_b16 v[138:139], v176 offset:25600
    ds_read_b64_tr_b16 v[140:141], v177 offset:24576
    ds_read_b64_tr_b16 v[142:143], v177 offset:25600
    v_mfma_f32_32x32x16_bf16 v[0:15], v[144:147], v[164:167], v[0:15]
    s_mov_b32 s76, 384
    s_add_u32 m0, s74, 0
    s_nop 0
    buffer_load_dwordx4 v188, s[40:43], s76 offen lds
    v_mfma_f32_32x32x16_bf16 v[16:31], v[148:151], v[164:167], v[16:31]
    s_mov_b32 s77, 1572864
    s_add_u32 m0, s75, 0
    s_nop 0
    buffer_load_dwordx4 v189, s[44:47], s77 offen lds
    v_mfma_f32_32x32x16_bf16 v[32:47], v[152:155], v[164:167], v[32:47]
    s_mov_b32 s77, 1605632
    s_add_u32 m0, s75, 1024
    s_nop 0
    buffer_load_dwordx4 v189, s[44:47], s77 offen lds
    v_mfma_f32_32x32x16_bf16 v[48:63], v[156:159], v[164:167], v[48:63]
    s_waitcnt lgkmcnt(6)
    ds_read_b128 v[164:167], v169 offset:24576
    ds_read_b64_tr_b16 v[144:145], v174 offset:28672
    ds_read_b64_tr_b16 v[146:147], v174 offset:29696
    ds_read_b64_tr_b16 v[148:149], v175 offset:28672
    ds_read_b64_tr_b16 v[150:151], v175 offset:29696
    ds_read_b64_tr_b16 v[152:153], v176 offset:28672
    ds_read_b64_tr_b16 v[154:155], v176 offset:29696
    ds_read_b64_tr_b16 v[156:157], v177 offset:28672
    ds_read_b64_tr_b16 v[158:159], v177 offset:29696
    s_waitcnt lgkmcnt(15)
    v_mfma_f32_32x32x16_bf16 v[0:15], v[128:131], v[160:163], v[0:15]
    buffer_load_dwordx4 v[68:71], v187, s[48:51], s67 offen offset:1024 sc0 sc1 nt
    s_waitcnt lgkmcnt(13)
    v_mfma_f32_32x32x16_bf16 v[16:31], v[132:135], v[160:163], v[16:31]
    s_waitcnt lgkmcnt(11)
    v_mfma_f32_32x32x16_bf16 v[32:47], v[136:139], v[160:163], v[32:47]
    s_waitcnt lgkmcnt(9)
    v_mfma_f32_32x32x16_bf16 v[48:63], v[140:143], v[160:163], v[48:63]
    s_waitcnt lgkmcnt(0)
    s_waitcnt vmcnt(14)
    s_barrier
    ds_read_b128 v[160:163], v170 offset:0
    ds_read_b64_tr_b16 v[128:129], v178 offset:0
    ds_read_b64_tr_b16 v[130:131], v178 offset:1024
    ds_read_b64_tr_b16 v[132:133], v179 offset:0
    ds_read_b64_tr_b16 v[134:135], v179 offset:1024
    ds_read_b64_tr_b16 v[136:137], v180 offset:0
    ds_read_b64_tr_b16 v[138:139], v180 offset:1024
    ds_read_b64_tr_b16 v[140:141], v181 offset:0
    ds_read_b64_tr_b16 v[142:143], v181 offset:1024
    v_mfma_f32_32x32x16_bf16 v[0:15], v[144:147], v[164:167], v[0:15]
    s_mov_b32 s76, 448
    s_add_u32 m0, s74, 24576
    s_nop 0
    buffer_load_dwordx4 v188, s[40:43], s76 offen lds
    v_mfma_f32_32x32x16_bf16 v[16:31], v[148:151], v[164:167], v[16:31]
    s_mov_b32 s77, 1835008
    s_add_u32 m0, s75, 24576
    s_nop 0
    buffer_load_dwordx4 v189, s[44:47], s77 offen lds
    v_mfma_f32_32x32x16_bf16 v[32:47], v[152:155], v[164:167], v[32:47]
    s_mov_b32 s77, 1867776
    s_add_u32 m0, s75, 25600
    s_nop 0
    buffer_load_dwordx4 v189, s[44:47], s77 offen lds
    v_mfma_f32_32x32x16_bf16 v[48:63], v[156:159], v[164:167], v[48:63]
    s_waitcnt lgkmcnt(6)
    ds_read_b128 v[164:167], v171 offset:0
    ds_read_b64_tr_b16 v[144:145], v178 offset:4096
    ds_read_b64_tr_b16 v[146:147], v178 offset:5120
    ds_read_b64_tr_b16 v[148:149], v179 offset:4096
    ds_read_b64_tr_b16 v[150:151], v179 offset:5120
    ds_read_b64_tr_b16 v[152:153], v180 offset:4096
    ds_read_b64_tr_b16 v[154:155], v180 offset:5120
    ds_read_b64_tr_b16 v[156:157], v181 offset:4096
    ds_read_b64_tr_b16 v[158:159], v181 offset:5120
    s_waitcnt lgkmcnt(15)
    v_mfma_f32_32x32x16_bf16 v[0:15], v[128:131], v[160:163], v[0:15]
    buffer_load_dwordx4 v[72:75], v187, s[48:51], s67 offen offset:2048 sc0 sc1 nt
    s_waitcnt lgkmcnt(13)
    v_mfma_f32_32x32x16_bf16 v[16:31], v[132:135], v[160:163], v[16:31]
    s_waitcnt lgkmcnt(11)
    v_mfma_f32_32x32x16_bf16 v[32:47], v[136:139], v[160:163], v[32:47]
    s_waitcnt lgkmcnt(9)
    v_mfma_f32_32x32x16_bf16 v[48:63], v[140:143], v[160:163], v[48:63]
    s_waitcnt lgkmcnt(0)
    s_waitcnt vmcnt(15)
    s_barrier
    ds_read_b128 v[160:163], v170 offset:24576
    ds_read_b64_tr_b16 v[128:129], v178 offset:24576
    ds_read_b64_tr_b16 v[130:131], v178 offset:25600
    ds_read_b64_tr_b16 v[132:133], v179 offset:24576
    ds_read_b64_tr_b16 v[134:135], v179 offset:25600
    ds_read_b64_tr_b16 v[136:137], v180 offset:24576
    ds_read_b64_tr_b16 v[138:139], v180 offset:25600
    ds_read_b64_tr_b16 v[140:141], v181 offset:24576
    ds_read_b64_tr_b16 v[142:143], v181 offset:25600
    v_mfma_f32_32x32x16_bf16 v[0:15], v[144:147], v[164:167], v[0:15]
    s_mov_b32 s76, 512
    s_add_u32 m0, s74, 49152
    s_nop 0
    buffer_load_dwordx4 v188, s[40:43], s76 offen lds
    v_mfma_f32_32x32x16_bf16 v[16:31], v[148:151], v[164:167], v[16:31]
    s_mov_b32 s77, 2097152
    s_add_u32 m0, s75, 49152
    s_nop 0
    buffer_load_dwordx4 v189, s[44:47], s77 offen lds
    v_mfma_f32_32x32x16_bf16 v[32:47], v[152:155], v[164:167], v[32:47]
    s_mov_b32 s77, 2129920
    s_add_u32 m0, s75, 50176
    s_nop 0
    buffer_load_dwordx4 v189, s[44:47], s77 offen lds
    v_mfma_f32_32x32x16_bf16 v[48:63], v[156:159], v[164:167], v[48:63]
    s_waitcnt lgkmcnt(6)
    ds_read_b128 v[164:167], v171 offset:24576
    ds_read_b64_tr_b16 v[144:145], v178 offset:28672
    ds_read_b64_tr_b16 v[146:147], v178 offset:29696
    ds_read_b64_tr_b16 v[148:149], v179 offset:28672
    ds_read_b64_tr_b16 v[150:151], v179 offset:29696
    ds_read_b64_tr_b16 v[152:153], v180 offset:28672
    ds_read_b64_tr_b16 v[154:155], v180 offset:29696
    ds_read_b64_tr_b16 v[156:157], v181 offset:28672
    ds_read_b64_tr_b16 v[158:159], v181 offset:29696
    s_waitcnt lgkmcnt(15)
    v_mfma_f32_32x32x16_bf16 v[0:15], v[128:131], v[160:163], v[0:15]
    buffer_load_dwordx4 v[76:79], v187, s[48:51], s67 offen offset:3072 sc0 sc1 nt
    s_waitcnt lgkmcnt(13)
    v_mfma_f32_32x32x16_bf16 v[16:31], v[132:135], v[160:163], v[16:31]
    s_waitcnt lgkmcnt(11)
    v_mfma_f32_32x32x16_bf16 v[32:47], v[136:139], v[160:163], v[32:47]
    s_waitcnt lgkmcnt(9)
    v_mfma_f32_32x32x16_bf16 v[48:63], v[140:143], v[160:163], v[48:63]
    s_waitcnt lgkmcnt(0)
    s_waitcnt vmcnt(16)
    s_barrier
    ds_read_b128 v[160:163], v172 offset:0
    ds_read_b64_tr_b16 v[128:129], v182 offset:0
    ds_read_b64_tr_b16 v[130:131], v182 offset:1024
    ds_read_b64_tr_b16 v[132:133], v183 offset:0
    ds_read_b64_tr_b16 v[134:135], v183 offset:1024
    ds_read_b64_tr_b16 v[136:137], v184 offset:0
    ds_read_b64_tr_b16 v[138:139], v184 offset:1024
    ds_read_b64_tr_b16 v[140:141], v185 offset:0
    ds_read_b64_tr_b16 v[142:143], v185 offset:1024
    v_mfma_f32_32x32x16_bf16 v[0:15], v[144:147], v[164:167], v[0:15]
    s_mov_b32 s76, 576
    s_add_u32 m0, s74, 73728
    s_nop 0
    buffer_load_dwordx4 v188, s[40:43], s76 offen lds
    v_mfma_f32_32x32x16_bf16 v[16:31], v[148:151], v[164:167], v[16:31]
    s_mov_b32 s77, 2359296
    s_add_u32 m0, s75, 73728
    s_nop 0
    buffer_load_dwordx4 v189, s[44:47], s77 offen lds
    v_mfma_f32_32x32x16_bf16 v[32:47], v[152:155], v[164:167], v[32:47]
    s_mov_b32 s77, 2392064
    s_add_u32 m0, s75, 74752
    s_nop 0
    buffer_load_dwordx4 v189, s[44:47], s77 offen lds
    v_mfma_f32_32x32x16_bf16 v[48:63], v[156:159], v[164:167], v[48:63]
    s_waitcnt lgkmcnt(6)
    ds_read_b128 v[164:167], v173 offset:0
    ds_read_b64_tr_b16 v[144:145], v182 offset:4096
    ds_read_b64_tr_b16 v[146:147], v182 offset:5120
    ds_read_b64_tr_b16 v[148:149], v183 offset:4096
    ds_read_b64_tr_b16 v[150:151], v183 offset:5120
    ds_read_b64_tr_b16 v[152:153], v184 offset:4096
    ds_read_b64_tr_b16 v[154:155], v184 offset:5120
    ds_read_b64_tr_b16 v[156:157], v185 offset:4096
    ds_read_b64_tr_b16 v[158:159], v185 offset:5120
    s_waitcnt lgkmcnt(15)
    v_mfma_f32_32x32x16_bf16 v[0:15], v[128:131], v[160:163], v[0:15]
    buffer_load_dwordx4 v[80:83], v187, s[48:51], s68 offen offset:0 sc0 sc1 nt
    s_waitcnt lgkmcnt(13)
    v_mfma_f32_32x32x16_bf16 v[16:31], v[132:135], v[160:163], v[16:31]
    s_waitcnt lgkmcnt(11)
    v_mfma_f32_32x32x16_bf16 v[32:47], v[136:139], v[160:163], v[32:47]
    s_waitcnt lgkmcnt(9)
    v_mfma_f32_32x32x16_bf16 v[48:63], v[140:143], v[160:163], v[48:63]
    s_waitcnt lgkmcnt(0)
    s_waitcnt vmcnt(17)
    s_barrier
    ds_read_b128 v[160:163], v172 offset:24576
    ds_read_b64_tr_b16 v[128:129], v182 offset:24576
    ds_read_b64_tr_b16 v[130:131], v182 offset:25600
    ds_read_b64_tr_b16 v[132:133], v183 offset:24576
    ds_read_b64_tr_b16 v[134:135], v183 offset:25600
    ds_read_b64_tr_b16 v[136:137], v184 offset:24576
    ds_read_b64_tr_b16 v[138:139], v184 offset:25600
    ds_read_b64_tr_b16 v[140:141], v185 offset:24576
    ds_read_b64_tr_b16 v[142:143], v185 offset:25600
    v_mfma_f32_32x32x16_bf16 v[0:15], v[144:147], v[164:167], v[0:15]
    s_mov_b32 s76, 640
    s_add_u32 m0, s74, 98304
    s_nop 0
    buffer_load_dwordx4 v188, s[40:43], s76 offen lds
    v_mfma_f32_32x32x16_bf16 v[16:31], v[148:151], v[164:167], v[16:31]
    s_mov_b32 s77, 2621440
    s_add_u32 m0, s75, 98304
    s_nop 0
    buffer_load_dwordx4 v189, s[44:47], s77 offen lds
    v_mfma_f32_32x32x16_bf16 v[32:47], v[152:155], v[164:167], v[32:47]
    s_mov_b32 s77, 2654208
    s_add_u32 m0, s75, 99328
    s_nop 0
    buffer_load_dwordx4 v189, s[44:47], s77 offen lds
    v_mfma_f32_32x32x16_bf16 v[48:63], v[156:159], v[164:167], v[48:63]
    s_waitcnt lgkmcnt(6)
    ds_read_b128 v[164:167], v173 offset:24576
    ds_read_b64_tr_b16 v[144:145], v182 offset:28672
    ds_read_b64_tr_b16 v[146:147], v182 offset:29696
    ds_read_b64_tr_b16 v[148:149], v183 offset:28672
    ds_read_b64_tr_b16 v[150:151], v183 offset:29696
    ds_read_b64_tr_b16 v[152:153], v184 offset:28672
    ds_read_b64_tr_b16 v[154:155], v184 offset:29696
    ds_read_b64_tr_b16 v[156:157], v185 offset:28672
    ds_read_b64_tr_b16 v[158:159], v185 offset:29696
    s_waitcnt lgkmcnt(15)
    v_mfma_f32_32x32x16_bf16 v[0:15], v[128:131], v[160:163], v[0:15]
    buffer_load_dwordx4 v[84:87], v187, s[48:51], s68 offen offset:1024 sc0 sc1 nt
    s_waitcnt lgkmcnt(13)
    v_mfma_f32_32x32x16_bf16 v[16:31], v[132:135], v[160:163], v[16:31]
    buffer_load_dwordx4 v[204:207], v187, s[4:7], s9 offen offset:0
    s_waitcnt lgkmcnt(11)
    v_mfma_f32_32x32x16_bf16 v[32:47], v[136:139], v[160:163], v[32:47]
    s_waitcnt lgkmcnt(9)
    v_mfma_f32_32x32x16_bf16 v[48:63], v[140:143], v[160:163], v[48:63]
    s_waitcnt lgkmcnt(0)
    s_waitcnt vmcnt(18)
    s_barrier
    ds_read_b128 v[160:163], v168 offset:0
    ds_read_b64_tr_b16 v[128:129], v174 offset:0
    ds_read_b64_tr_b16 v[130:131], v174 offset:1024
    ds_read_b64_tr_b16 v[132:133], v175 offset:0
    ds_read_b64_tr_b16 v[134:135], v175 offset:1024
    ds_read_b64_tr_b16 v[136:137], v176 offset:0
    ds_read_b64_tr_b16 v[138:139], v176 offset:1024
    ds_read_b64_tr_b16 v[140:141], v177 offset:0
    ds_read_b64_tr_b16 v[142:143], v177 offset:1024
    v_mfma_f32_32x32x16_bf16 v[0:15], v[144:147], v[164:167], v[0:15]
    s_mov_b32 s76, 704
    s_add_u32 m0, s74, 122880
    s_nop 0
    buffer_load_dwordx4 v188, s[40:43], s76 offen lds
    v_mfma_f32_32x32x16_bf16 v[16:31], v[148:151], v[164:167], v[16:31]
    s_mov_b32 s77, 2883584
    s_add_u32 m0, s75, 122880
    s_nop 0
    buffer_load_dwordx4 v189, s[44:47], s77 offen lds
    v_mfma_f32_32x32x16_bf16 v[32:47], v[152:155], v[164:167], v[32:47]
    s_mov_b32 s77, 2916352
    s_add_u32 m0, s75, 123904
    s_nop 0
    buffer_load_dwordx4 v189, s[44:47], s77 offen lds
    v_mfma_f32_32x32x16_bf16 v[48:63], v[156:159], v[164:167], v[48:63]
    s_waitcnt lgkmcnt(6)
    ds_read_b128 v[164:167], v169 offset:0
    ds_read_b64_tr_b16 v[144:145], v174 offset:4096
    ds_read_b64_tr_b16 v[146:147], v174 offset:5120
    ds_read_b64_tr_b16 v[148:149], v175 offset:4096
    ds_read_b64_tr_b16 v[150:151], v175 offset:5120
    ds_read_b64_tr_b16 v[152:153], v176 offset:4096
    ds_read_b64_tr_b16 v[154:155], v176 offset:5120
    ds_read_b64_tr_b16 v[156:157], v177 offset:4096
    ds_read_b64_tr_b16 v[158:159], v177 offset:5120
    s_waitcnt lgkmcnt(15)
    v_mfma_f32_32x32x16_bf16 v[0:15], v[128:131], v[160:163], v[0:15]
    buffer_load_dwordx4 v[88:91], v187, s[48:51], s68 offen offset:2048 sc0 sc1 nt
    s_waitcnt lgkmcnt(13)
    v_mfma_f32_32x32x16_bf16 v[16:31], v[132:135], v[160:163], v[16:31]
    s_waitcnt lgkmcnt(11)
    v_mfma_f32_32x32x16_bf16 v[32:47], v[136:139], v[160:163], v[32:47]
    s_waitcnt lgkmcnt(9)
    v_mfma_f32_32x32x16_bf16 v[48:63], v[140:143], v[160:163], v[48:63]
    s_waitcnt lgkmcnt(0)
    s_waitcnt vmcnt(18)
    s_barrier
    ds_read_b128 v[160:163], v168 offset:24576
    ds_read_b64_tr_b16 v[128:129], v174 offset:24576
    ds_read_b64_tr_b16 v[130:131], v174 offset:25600
    ds_read_b64_tr_b16 v[132:133], v175 offset:24576
    ds_read_b64_tr_b16 v[134:135], v175 offset:25600
    ds_read_b64_tr_b16 v[136:137], v176 offset:24576
    ds_read_b64_tr_b16 v[138:139], v176 offset:25600
    ds_read_b64_tr_b16 v[140:141], v177 offset:24576
    ds_read_b64_tr_b16 v[142:143], v177 offset:25600
    v_mfma_f32_32x32x16_bf16 v[0:15], v[144:147], v[164:167], v[0:15]
    s_mov_b32 s76, 768
    s_add_u32 m0, s74, 0
    s_nop 0
    buffer_load_dwordx4 v188, s[40:43], s76 offen lds
    v_mfma_f32_32x32x16_bf16 v[16:31], v[148:151], v[164:167], v[16:31]
    s_mov_b32 s77, 3145728
    s_add_u32 m0, s75, 0
    s_nop 0
    buffer_load_dwordx4 v189, s[44:47], s77 offen lds
    v_mfma_f32_32x32x16_bf16 v[32:47], v[152:155], v[164:167], v[32:47]
    s_mov_b32 s77, 3178496
    s_add_u32 m0, s75, 1024
    s_nop 0
    buffer_load_dwordx4 v189, s[44:47], s77 offen lds
    v_mfma_f32_32x32x16_bf16 v[48:63], v[156:159], v[164:167], v[48:63]
    s_waitcnt lgkmcnt(6)
    ds_read_b128 v[164:167], v169 offset:24576
    ds_read_b64_tr_b16 v[144:145], v174 offset:28672
    ds_read_b64_tr_b16 v[146:147], v174 offset:29696
    ds_read_b64_tr_b16 v[148:149], v175 offset:28672
    ds_read_b64_tr_b16 v[150:151], v175 offset:29696
    ds_read_b64_tr_b16 v[152:153], v176 offset:28672
    ds_read_b64_tr_b16 v[154:155], v176 offset:29696
    ds_read_b64_tr_b16 v[156:157], v177 offset:28672
    ds_read_b64_tr_b16 v[158:159], v177 offset:29696
    s_waitcnt lgkmcnt(15)
    v_mfma_f32_32x32x16_bf16 v[0:15], v[128:131], v[160:163], v[0:15]
    buffer_load_dwordx4 v[92:95], v187, s[48:51], s68 offen offset:3072 sc0 sc1 nt
    s_waitcnt lgkmcnt(13)
    v_mfma_f32_32x32x16_bf16 v[16:31], v[132:135], v[160:163], v[16:31]
    buffer_load_dwordx4 v[208:211], v187, s[4:7], s9 offen offset:1024
    s_waitcnt lgkmcnt(11)
    v_mfma_f32_32x32x16_bf16 v[32:47], v[136:139], v[160:163], v[32:47]
    s_waitcnt lgkmcnt(9)
    v_mfma_f32_32x32x16_bf16 v[48:63], v[140:143], v[160:163], v[48:63]
    s_waitcnt lgkmcnt(0)
    s_waitcnt vmcnt(19)
    s_barrier
    ds_read_b128 v[160:163], v170 offset:0
    ds_read_b64_tr_b16 v[128:129], v178 offset:0
    ds_read_b64_tr_b16 v[130:131], v178 offset:1024
    ds_read_b64_tr_b16 v[132:133], v179 offset:0
    ds_read_b64_tr_b16 v[134:135], v179 offset:1024
    ds_read_b64_tr_b16 v[136:137], v180 offset:0
    ds_read_b64_tr_b16 v[138:139], v180 offset:1024
    ds_read_b64_tr_b16 v[140:141], v181 offset:0
    ds_read_b64_tr_b16 v[142:143], v181 offset:1024
    v_mfma_f32_32x32x16_bf16 v[0:15], v[144:147], v[164:167], v[0:15]
    s_mov_b32 s76, 832
    s_add_u32 m0, s74, 24576
    s_nop 0
    buffer_load_dwordx4 v188, s[40:43], s76 offen lds
    v_mfma_f32_32x32x16_bf16 v[16:31], v[148:151], v[164:167], v[16:31]
    s_mov_b32 s77, 3407872
    s_add_u32 m0, s75, 24576
    s_nop 0
    buffer_load_dwordx4 v189, s[44:47], s77 offen lds
    v_mfma_f32_32x32x16_bf16 v[32:47], v[152:155], v[164:167], v[32:47]
    s_mov_b32 s77, 3440640
    s_add_u32 m0, s75, 25600
    s_nop 0
    buffer_load_dwordx4 v189, s[44:47], s77 offen lds
    v_mfma_f32_32x32x16_bf16 v[48:63], v[156:159], v[164:167], v[48:63]
    s_waitcnt lgkmcnt(6)
    ds_read_b128 v[164:167], v171 offset:0
    ds_read_b64_tr_b16 v[144:145], v178 offset:4096
    ds_read_b64_tr_b16 v[146:147], v178 offset:5120
    ds_read_b64_tr_b16 v[148:149], v179 offset:4096
    ds_read_b64_tr_b16 v[150:151], v179 offset:5120
    ds_read_b64_tr_b16 v[152:153], v180 offset:4096
    ds_read_b64_tr_b16 v[154:155], v180 offset:5120
    ds_read_b64_tr_b16 v[156:157], v181 offset:4096
    ds_read_b64_tr_b16 v[158:159], v181 offset:5120
    s_waitcnt lgkmcnt(15)
    v_mfma_f32_32x32x16_bf16 v[0:15], v[128:131], v[160:163], v[0:15]
    buffer_load_dwordx4 v[96:99], v187, s[52:55], s67 offen offset:0 sc0 sc1 nt
    s_waitcnt lgkmcnt(13)
    v_mfma_f32_32x32x16_bf16 v[16:31], v[132:135], v[160:163], v[16:31]
    s_waitcnt lgkmcnt(11)
    v_mfma_f32_32x32x16_bf16 v[32:47], v[136:139], v[160:163], v[32:47]
    s_waitcnt lgkmcnt(9)
    v_mfma_f32_32x32x16_bf16 v[48:63], v[140:143], v[160:163], v[48:63]
    s_waitcnt lgkmcnt(0)
    s_waitcnt vmcnt(19)
    s_barrier
    ds_read_b128 v[160:163], v170 offset:24576
    ds_read_b64_tr_b16 v[128:129], v178 offset:24576
    ds_read_b64_tr_b16 v[130:131], v178 offset:25600
    ds_read_b64_tr_b16 v[132:133], v179 offset:24576
    ds_read_b64_tr_b16 v[134:135], v179 offset:25600
    ds_read_b64_tr_b16 v[136:137], v180 offset:24576
    ds_read_b64_tr_b16 v[138:139], v180 offset:25600
    ds_read_b64_tr_b16 v[140:141], v181 offset:24576
    ds_read_b64_tr_b16 v[142:143], v181 offset:25600
    v_mfma_f32_32x32x16_bf16 v[0:15], v[144:147], v[164:167], v[0:15]
    s_mov_b32 s76, 896
    s_add_u32 m0, s74, 49152
    s_nop 0
    buffer_load_dwordx4 v188, s[40:43], s76 offen lds
    v_mfma_f32_32x32x16_bf16 v[16:31], v[148:151], v[164:167], v[16:31]
    s_mov_b32 s77, 3670016
    s_add_u32 m0, s75, 49152
    s_nop 0
    buffer_load_dwordx4 v189, s[44:47], s77 offen lds
    v_mfma_f32_32x32x16_bf16 v[32:47], v[152:155], v[164:167], v[32:47]
    s_mov_b32 s77, 3702784
    s_add_u32 m0, s75, 50176
    s_nop 0
    buffer_load_dwordx4 v189, s[44:47], s77 offen lds
    v_mfma_f32_32x32x16_bf16 v[48:63], v[156:159], v[164:167], v[48:63]
    s_waitcnt lgkmcnt(6)
    ds_read_b128 v[164:167], v171 offset:24576
    ds_read_b64_tr_b16 v[144:145], v178 offset:28672
    ds_read_b64_tr_b16 v[146:147], v178 offset:29696
    ds_read_b64_tr_b16 v[148:149], v179 offset:28672
    ds_read_b64_tr_b16 v[150:151], v179 offset:29696
    ds_read_b64_tr_b16 v[152:153], v180 offset:28672
    ds_read_b64_tr_b16 v[154:155], v180 offset:29696
    ds_read_b64_tr_b16 v[156:157], v181 offset:28672
    ds_read_b64_tr_b16 v[158:159], v181 offset:29696
    s_waitcnt lgkmcnt(15)
    v_mfma_f32_32x32x16_bf16 v[0:15], v[128:131], v[160:163], v[0:15]
    buffer_load_dwordx4 v[100:103], v187, s[52:55], s67 offen offset:1024 sc0 sc1 nt
    s_waitcnt lgkmcnt(13)
    v_mfma_f32_32x32x16_bf16 v[16:31], v[132:135], v[160:163], v[16:31]
    buffer_load_dwordx4 v[204:207], v187, s[4:7], s9 offen offset:2048
    s_waitcnt lgkmcnt(11)
    v_mfma_f32_32x32x16_bf16 v[32:47], v[136:139], v[160:163], v[32:47]
    s_waitcnt lgkmcnt(9)
    v_mfma_f32_32x32x16_bf16 v[48:63], v[140:143], v[160:163], v[48:63]
    s_waitcnt lgkmcnt(0)
    s_waitcnt vmcnt(20)
    s_barrier
    ds_read_b128 v[160:163], v172 offset:0
    ds_read_b64_tr_b16 v[128:129], v182 offset:0
    ds_read_b64_tr_b16 v[130:131], v182 offset:1024
    ds_read_b64_tr_b16 v[132:133], v183 offset:0
    ds_read_b64_tr_b16 v[134:135], v183 offset:1024
    ds_read_b64_tr_b16 v[136:137], v184 offset:0
    ds_read_b64_tr_b16 v[138:139], v184 offset:1024
    ds_read_b64_tr_b16 v[140:141], v185 offset:0
    ds_read_b64_tr_b16 v[142:143], v185 offset:1024
    v_mfma_f32_32x32x16_bf16 v[0:15], v[144:147], v[164:167], v[0:15]
    s_mov_b32 s76, 960
    s_add_u32 m0, s74, 73728
    s_nop 0
    buffer_load_dwordx4 v188, s[40:43], s76 offen lds
    v_mfma_f32_32x32x16_bf16 v[16:31], v[148:151], v[164:167], v[16:31]
    s_mov_b32 s77, 3932160
    s_add_u32 m0, s75, 73728
    s_nop 0
    buffer_load_dwordx4 v189, s[44:47], s77 offen lds
    v_mfma_f32_32x32x16_bf16 v[32:47], v[152:155], v[164:167], v[32:47]
    s_mov_b32 s77, 3964928
    s_add_u32 m0, s75, 74752
    s_nop 0
    buffer_load_dwordx4 v189, s[44:47], s77 offen lds
    v_mfma_f32_32x32x16_bf16 v[48:63], v[156:159], v[164:167], v[48:63]
    s_waitcnt lgkmcnt(6)
    ds_read_b128 v[164:167], v173 offset:0
    ds_read_b64_tr_b16 v[144:145], v182 offset:4096
    ds_read_b64_tr_b16 v[146:147], v182 offset:5120
    ds_read_b64_tr_b16 v[148:149], v183 offset:4096
    ds_read_b64_tr_b16 v[150:151], v183 offset:5120
    ds_read_b64_tr_b16 v[152:153], v184 offset:4096
    ds_read_b64_tr_b16 v[154:155], v184 offset:5120
    ds_read_b64_tr_b16 v[156:157], v185 offset:4096
    ds_read_b64_tr_b16 v[158:159], v185 offset:5120
    s_waitcnt lgkmcnt(15)
    v_mfma_f32_32x32x16_bf16 v[0:15], v[128:131], v[160:163], v[0:15]
    buffer_load_dwordx4 v[104:107], v187, s[52:55], s67 offen offset:2048 sc0 sc1 nt
    s_cmp_lg_u32 s60, 0
    s_cbranch_scc1 F_NON_SKIP
    s_mov_b32 s12, s28
    s_and_b32 s13, s29, 0xffff
    s_mov_b32 s14, 0x100
    s_mov_b32 s15, 0x00020000
    s_memrealtime s[10:11]
    s_waitcnt lgkmcnt(0)
    s_or_b32 s8, s10, 1
    v_mov_b32 v212, s8
    v_mov_b32 v213, 0
    v_mov_b32 v214, 128
    v_cmp_eq_u32 vcc, 0, v200
    s_and_saveexec_b64 s[10:11], vcc
    buffer_atomic_cmpswap v[212:213], v214, s[12:15], 0 offen sc0 sc1
    s_mov_b64 exec, s[10:11]
F_NON_SKIP:
    s_waitcnt lgkmcnt(13)
    v_mfma_f32_32x32x16_bf16 v[16:31], v[132:135], v[160:163], v[16:31]
    s_waitcnt lgkmcnt(11)
    v_mfma_f32_32x32x16_bf16 v[32:47], v[136:139], v[160:163], v[32:47]
    s_waitcnt lgkmcnt(9)
    v_mfma_f32_32x32x16_bf16 v[48:63], v[140:143], v[160:163], v[48:63]
    s_waitcnt lgkmcnt(0)
    s_waitcnt vmcnt(19)
    s_barrier
    ds_read_b128 v[160:163], v172 offset:24576
    ds_read_b64_tr_b16 v[128:129], v182 offset:24576
    ds_read_b64_tr_b16 v[130:131], v182 offset:25600
    ds_read_b64_tr_b16 v[132:133], v183 offset:24576
    ds_read_b64_tr_b16 v[134:135], v183 offset:25600
    ds_read_b64_tr_b16 v[136:137], v184 offset:24576
    ds_read_b64_tr_b16 v[138:139], v184 offset:25600
    ds_read_b64_tr_b16 v[140:141], v185 offset:24576
    ds_read_b64_tr_b16 v[142:143], v185 offset:25600
    v_mfma_f32_32x32x16_bf16 v[0:15], v[144:147], v[164:167], v[0:15]
    v_mfma_f32_32x32x16_bf16 v[16:31], v[148:151], v[164:167], v[16:31]
    v_mfma_f32_32x32x16_bf16 v[32:47], v[152:155], v[164:167], v[32:47]
    v_mfma_f32_32x32x16_bf16 v[48:63], v[156:159], v[164:167], v[48:63]
    s_waitcnt lgkmcnt(6)
    ds_read_b128 v[164:167], v173 offset:24576
    ds_read_b64_tr_b16 v[144:145], v182 offset:28672
    ds_read_b64_tr_b16 v[146:147], v182 offset:29696
    ds_read_b64_tr_b16 v[148:149], v183 offset:28672
    ds_read_b64_tr_b16 v[150:151], v183 offset:29696
    ds_read_b64_tr_b16 v[152:153], v184 offset:28672
    ds_read_b64_tr_b16 v[154:155], v184 offset:29696
    ds_read_b64_tr_b16 v[156:157], v185 offset:28672
    ds_read_b64_tr_b16 v[158:159], v185 offset:29696
    s_waitcnt lgkmcnt(15)
    v_mfma_f32_32x32x16_bf16 v[0:15], v[128:131], v[160:163], v[0:15]
    buffer_load_dwordx4 v[108:111], v187, s[52:55], s67 offen offset:3072 sc0 sc1 nt
    s_waitcnt lgkmcnt(13)
    v_mfma_f32_32x32x16_bf16 v[16:31], v[132:135], v[160:163], v[16:31]
    buffer_load_dwordx4 v[208:211], v187, s[4:7], s9 offen offset:3072
    s_waitcnt lgkmcnt(11)
    v_mfma_f32_32x32x16_bf16 v[32:47], v[136:139], v[160:163], v[32:47]
    s_waitcnt lgkmcnt(9)
    v_mfma_f32_32x32x16_bf16 v[48:63], v[140:143], v[160:163], v[48:63]
    s_waitcnt lgkmcnt(0)
    s_waitcnt vmcnt(17)
    s_barrier
    ds_read_b128 v[160:163], v168 offset:0
    ds_read_b64_tr_b16 v[128:129], v174 offset:0
    ds_read_b64_tr_b16 v[130:131], v174 offset:1024
    ds_read_b64_tr_b16 v[132:133], v175 offset:0
    ds_read_b64_tr_b16 v[134:135], v175 offset:1024
    ds_read_b64_tr_b16 v[136:137], v176 offset:0
    ds_read_b64_tr_b16 v[138:139], v176 offset:1024
    ds_read_b64_tr_b16 v[140:141], v177 offset:0
    ds_read_b64_tr_b16 v[142:143], v177 offset:1024
    v_mfma_f32_32x32x16_bf16 v[0:15], v[144:147], v[164:167], v[0:15]
    v_mfma_f32_32x32x16_bf16 v[16:31], v[148:151], v[164:167], v[16:31]
    v_mfma_f32_32x32x16_bf16 v[32:47], v[152:155], v[164:167], v[32:47]
    v_mfma_f32_32x32x16_bf16 v[48:63], v[156:159], v[164:167], v[48:63]
    s_waitcnt lgkmcnt(6)
    ds_read_b128 v[164:167], v169 offset:0
    ds_read_b64_tr_b16 v[144:145], v174 offset:4096
    ds_read_b64_tr_b16 v[146:147], v174 offset:5120
    ds_read_b64_tr_b16 v[148:149], v175 offset:4096
    ds_read_b64_tr_b16 v[150:151], v175 offset:5120
    ds_read_b64_tr_b16 v[152:153], v176 offset:4096
    ds_read_b64_tr_b16 v[154:155], v176 offset:5120
    ds_read_b64_tr_b16 v[156:157], v177 offset:4096
    ds_read_b64_tr_b16 v[158:159], v177 offset:5120
    s_waitcnt lgkmcnt(15)
    v_mfma_f32_32x32x16_bf16 v[0:15], v[128:131], v[160:163], v[0:15]
    buffer_load_dwordx4 v[112:115], v187, s[52:55], s68 offen offset:0 sc0 sc1 nt
    s_waitcnt lgkmcnt(13)
    v_mfma_f32_32x32x16_bf16 v[16:31], v[132:135], v[160:163], v[16:31]
    s_waitcnt lgkmcnt(11)
    v_mfma_f32_32x32x16_bf16 v[32:47], v[136:139], v[160:163], v[32:47]
    s_waitcnt lgkmcnt(9)
    v_mfma_f32_32x32x16_bf16 v[48:63], v[140:143], v[160:163], v[48:63]
    s_waitcnt lgkmcnt(0)
    s_waitcnt vmcnt(13)
    s_barrier
    ds_read_b128 v[160:163], v168 offset:24576
    ds_read_b64_tr_b16 v[128:129], v174 offset:24576
    ds_read_b64_tr_b16 v[130:131], v174 offset:25600
    ds_read_b64_tr_b16 v[132:133], v175 offset:24576
    ds_read_b64_tr_b16 v[134:135], v175 offset:25600
    ds_read_b64_tr_b16 v[136:137], v176 offset:24576
    ds_read_b64_tr_b16 v[138:139], v176 offset:25600
    ds_read_b64_tr_b16 v[140:141], v177 offset:24576
    ds_read_b64_tr_b16 v[142:143], v177 offset:25600
    v_mfma_f32_32x32x16_bf16 v[0:15], v[144:147], v[164:167], v[0:15]
    v_mfma_f32_32x32x16_bf16 v[16:31], v[148:151], v[164:167], v[16:31]
    v_mfma_f32_32x32x16_bf16 v[32:47], v[152:155], v[164:167], v[32:47]
    v_mfma_f32_32x32x16_bf16 v[48:63], v[156:159], v[164:167], v[48:63]
    s_waitcnt lgkmcnt(6)
    ds_read_b128 v[164:167], v169 offset:24576
    ds_read_b64_tr_b16 v[144:145], v174 offset:28672
    ds_read_b64_tr_b16 v[146:147], v174 offset:29696
    ds_read_b64_tr_b16 v[148:149], v175 offset:28672
    ds_read_b64_tr_b16 v[150:151], v175 offset:29696
    ds_read_b64_tr_b16 v[152:153], v176 offset:28672
    ds_read_b64_tr_b16 v[154:155], v176 offset:29696
    ds_read_b64_tr_b16 v[156:157], v177 offset:28672
    ds_read_b64_tr_b16 v[158:159], v177 offset:29696
    s_waitcnt lgkmcnt(15)
    v_mfma_f32_32x32x16_bf16 v[0:15], v[128:131], v[160:163], v[0:15]
    buffer_load_dwordx4 v[116:119], v187, s[52:55], s68 offen offset:1024 sc0 sc1 nt
    s_waitcnt lgkmcnt(13)
    v_mfma_f32_32x32x16_bf16 v[16:31], v[132:135], v[160:163], v[16:31]
    s_waitcnt lgkmcnt(11)
    v_mfma_f32_32x32x16_bf16 v[32:47], v[136:139], v[160:163], v[32:47]
    s_waitcnt lgkmcnt(9)
    v_mfma_f32_32x32x16_bf16 v[48:63], v[140:143], v[160:163], v[48:63]
    s_waitcnt lgkmcnt(0)
    s_waitcnt vmcnt(10)
    s_barrier
    ds_read_b128 v[160:163], v170 offset:0
    ds_read_b64_tr_b16 v[128:129], v178 offset:0
    ds_read_b64_tr_b16 v[130:131], v178 offset:1024
    ds_read_b64_tr_b16 v[132:133], v179 offset:0
    ds_read_b64_tr_b16 v[134:135], v179 offset:1024
    ds_read_b64_tr_b16 v[136:137], v180 offset:0
    ds_read_b64_tr_b16 v[138:139], v180 offset:1024
    ds_read_b64_tr_b16 v[140:141], v181 offset:0
    ds_read_b64_tr_b16 v[142:143], v181 offset:1024
    v_mfma_f32_32x32x16_bf16 v[0:15], v[144:147], v[164:167], v[0:15]
    v_mfma_f32_32x32x16_bf16 v[16:31], v[148:151], v[164:167], v[16:31]
    v_mfma_f32_32x32x16_bf16 v[32:47], v[152:155], v[164:167], v[32:47]
    v_mfma_f32_32x32x16_bf16 v[48:63], v[156:159], v[164:167], v[48:63]
    s_waitcnt lgkmcnt(6)
    ds_read_b128 v[164:167], v171 offset:0
    ds_read_b64_tr_b16 v[144:145], v178 offset:4096
    ds_read_b64_tr_b16 v[146:147], v178 offset:5120
    ds_read_b64_tr_b16 v[148:149], v179 offset:4096
    ds_read_b64_tr_b16 v[150:151], v179 offset:5120
    ds_read_b64_tr_b16 v[152:153], v180 offset:4096
    ds_read_b64_tr_b16 v[154:155], v180 offset:5120
    ds_read_b64_tr_b16 v[156:157], v181 offset:4096
    ds_read_b64_tr_b16 v[158:159], v181 offset:5120
    s_waitcnt lgkmcnt(15)
    v_mfma_f32_32x32x16_bf16 v[0:15], v[128:131], v[160:163], v[0:15]
    buffer_load_dwordx4 v[120:123], v187, s[52:55], s68 offen offset:2048 sc0 sc1 nt
    s_waitcnt lgkmcnt(13)
    v_mfma_f32_32x32x16_bf16 v[16:31], v[132:135], v[160:163], v[16:31]
    s_waitcnt lgkmcnt(11)
    v_mfma_f32_32x32x16_bf16 v[32:47], v[136:139], v[160:163], v[32:47]
    s_waitcnt lgkmcnt(9)
    v_mfma_f32_32x32x16_bf16 v[48:63], v[140:143], v[160:163], v[48:63]
    s_waitcnt lgkmcnt(0)
    s_waitcnt vmcnt(6)
    s_barrier
    ds_read_b128 v[160:163], v170 offset:24576
    ds_read_b64_tr_b16 v[128:129], v178 offset:24576
    ds_read_b64_tr_b16 v[130:131], v178 offset:25600
    ds_read_b64_tr_b16 v[132:133], v179 offset:24576
    ds_read_b64_tr_b16 v[134:135], v179 offset:25600
    ds_read_b64_tr_b16 v[136:137], v180 offset:24576
    ds_read_b64_tr_b16 v[138:139], v180 offset:25600
    ds_read_b64_tr_b16 v[140:141], v181 offset:24576
    ds_read_b64_tr_b16 v[142:143], v181 offset:25600
    v_mfma_f32_32x32x16_bf16 v[0:15], v[144:147], v[164:167], v[0:15]
    v_mfma_f32_32x32x16_bf16 v[16:31], v[148:151], v[164:167], v[16:31]
    v_mfma_f32_32x32x16_bf16 v[32:47], v[152:155], v[164:167], v[32:47]
    v_mfma_f32_32x32x16_bf16 v[48:63], v[156:159], v[164:167], v[48:63]
    s_waitcnt lgkmcnt(6)
    ds_read_b128 v[164:167], v171 offset:24576
    ds_read_b64_tr_b16 v[144:145], v178 offset:28672
    ds_read_b64_tr_b16 v[146:147], v178 offset:29696
    ds_read_b64_tr_b16 v[148:149], v179 offset:28672
    ds_read_b64_tr_b16 v[150:151], v179 offset:29696
    ds_read_b64_tr_b16 v[152:153], v180 offset:28672
    ds_read_b64_tr_b16 v[154:155], v180 offset:29696
    ds_read_b64_tr_b16 v[156:157], v181 offset:28672
    ds_read_b64_tr_b16 v[158:159], v181 offset:29696
    s_waitcnt lgkmcnt(15)
    v_mfma_f32_32x32x16_bf16 v[0:15], v[128:131], v[160:163], v[0:15]
    buffer_load_dwordx4 v[124:127], v187, s[52:55], s68 offen offset:3072 sc0 sc1 nt
    s_waitcnt lgkmcnt(13)
    v_mfma_f32_32x32x16_bf16 v[16:31], v[132:135], v[160:163], v[16:31]
    s_waitcnt lgkmcnt(11)
    v_mfma_f32_32x32x16_bf16 v[32:47], v[136:139], v[160:163], v[32:47]
    s_waitcnt lgkmcnt(9)
    v_mfma_f32_32x32x16_bf16 v[48:63], v[140:143], v[160:163], v[48:63]
    s_waitcnt lgkmcnt(0)
    v_mfma_f32_32x32x16_bf16 v[0:15], v[144:147], v[164:167], v[0:15]
    v_mfma_f32_32x32x16_bf16 v[16:31], v[148:151], v[164:167], v[16:31]
    v_mfma_f32_32x32x16_bf16 v[32:47], v[152:155], v[164:167], v[32:47]
    v_mfma_f32_32x32x16_bf16 v[48:63], v[156:159], v[164:167], v[48:63]
    s_barrier
    s_waitcnt vmcnt(0)
    s_mov_b32 s44, s24
    s_and_b32 s45, s25, 0xffff
    s_mov_b32 s46, 0x400000
    s_mov_b32 s47, 0x00020000
    v_lshrrev_b32 v195, 4, v200
    v_and_b32 v196, 15, v200
    v_lshlrev_b32 v197, 2, v195
    v_xor_b32 v196, v196, v197
    v_lshlrev_b32 v195, 8, v195
    v_lshl_add_u32 v195, v196, 4, v195
    s_lshl_b32 s70, s60, 13
    v_add_u32 v195, s70, v195
    v_lshrrev_b32 v198, 4, v200
    v_and_b32 v199, 15, v200
    v_xor_b32 v199, v199, v198
    v_lshlrev_b32 v198, 8, v198
    v_lshl_add_u32 v198, v199, 4, v198
    v_add_u32 v198, s70, v198
    v_add_u32 v198, 0x10000, v198
    v_xor_b32 v199, 0, v198
    ds_write_b128 v199, v[64:67] offset:0
    v_xor_b32 v199, 64, v198
    ds_write_b128 v199, v[68:71] offset:1024
    v_xor_b32 v199, 128, v198
    ds_write_b128 v199, v[72:75] offset:2048
    v_xor_b32 v199, 192, v198
    ds_write_b128 v199, v[76:79] offset:3072
    v_xor_b32 v199, 0, v198
    ds_write_b128 v199, v[80:83] offset:4096
    v_xor_b32 v199, 64, v198
    ds_write_b128 v199, v[84:87] offset:5120
    v_xor_b32 v199, 128, v198
    ds_write_b128 v199, v[88:91] offset:6144
    v_xor_b32 v199, 192, v198
    ds_write_b128 v199, v[92:95] offset:7168
    ds_write_b128 v195, v[96:99] offset:0
    ds_write_b128 v195, v[100:103] offset:1024
    ds_write_b128 v195, v[104:107] offset:2048
    ds_write_b128 v195, v[108:111] offset:3072
    ds_write_b128 v195, v[112:115] offset:4096
    ds_write_b128 v195, v[116:119] offset:5120
    ds_write_b128 v195, v[120:123] offset:6144
    ds_write_b128 v195, v[124:127] offset:7168
    v_and_b32 v196, 31, v200
    v_lshrrev_b32 v197, 5, v200
    v_and_b32 v199, 15, v196
    v_xor_b32 v199, v199, v197
    v_lshlrev_b32 v196, 8, v196
    v_lshl_add_u32 v196, v199, 4, v196
    v_add_u32 v196, s70, v196
    v_add_u32 v196, 0x10000, v196
    s_waitcnt lgkmcnt(7)
    v_xor_b32 v199, 0, v196
    ds_read_b128 v[64:67], v199
    v_xor_b32 v199, 32, v196
    ds_read_b128 v[68:71], v199
    v_xor_b32 v199, 64, v196
    ds_read_b128 v[72:75], v199
    v_xor_b32 v199, 96, v196
    ds_read_b128 v[76:79], v199
    v_xor_b32 v199, 128, v196
    ds_read_b128 v[80:83], v199
    v_xor_b32 v199, 160, v196
    ds_read_b128 v[84:87], v199
    v_xor_b32 v199, 192, v196
    ds_read_b128 v[88:91], v199
    v_xor_b32 v199, 224, v196
    ds_read_b128 v[92:95], v199
    v_lshl_add_u32 v194, v190, 2, v192
    v_lshl_add_u32 v194, v194, 8, v193
    v_add_u32 v194, s70, v194
    v_xor_b32 v191, 0, v192
    v_lshl_add_u32 v174, v191, 6, v194
    v_xor_b32 v191, 1, v192
    v_lshl_add_u32 v175, v191, 6, v194
    v_xor_b32 v191, 2, v192
    v_lshl_add_u32 v176, v191, 6, v194
    v_xor_b32 v191, 3, v192
    v_lshl_add_u32 v177, v191, 6, v194
    v_cvt_pk_bf16_f32 v128, v0, v1
    v_cvt_pk_bf16_f32 v129, v2, v3
    v_cvt_pk_bf16_f32 v130, v4, v5
    v_cvt_pk_bf16_f32 v131, v6, v7
    v_cvt_pk_bf16_f32 v132, v8, v9
    v_cvt_pk_bf16_f32 v133, v10, v11
    v_cvt_pk_bf16_f32 v134, v12, v13
    v_cvt_pk_bf16_f32 v135, v14, v15
    v_cvt_pk_bf16_f32 v136, v16, v17
    v_cvt_pk_bf16_f32 v137, v18, v19
    v_cvt_pk_bf16_f32 v138, v20, v21
    v_cvt_pk_bf16_f32 v139, v22, v23
    v_cvt_pk_bf16_f32 v140, v24, v25
    v_cvt_pk_bf16_f32 v141, v26, v27
    v_cvt_pk_bf16_f32 v142, v28, v29
    v_cvt_pk_bf16_f32 v143, v30, v31
    v_cvt_pk_bf16_f32 v144, v32, v33
    v_cvt_pk_bf16_f32 v145, v34, v35
    v_cvt_pk_bf16_f32 v146, v36, v37
    v_cvt_pk_bf16_f32 v147, v38, v39
    v_cvt_pk_bf16_f32 v148, v40, v41
    v_cvt_pk_bf16_f32 v149, v42, v43
    v_cvt_pk_bf16_f32 v150, v44, v45
    v_cvt_pk_bf16_f32 v151, v46, v47
    v_cvt_pk_bf16_f32 v152, v48, v49
    v_cvt_pk_bf16_f32 v153, v50, v51
    v_cvt_pk_bf16_f32 v154, v52, v53
    v_cvt_pk_bf16_f32 v155, v54, v55
    v_cvt_pk_bf16_f32 v156, v56, v57
    v_cvt_pk_bf16_f32 v157, v58, v59
    v_cvt_pk_bf16_f32 v158, v60, v61
    v_cvt_pk_bf16_f32 v159, v62, v63
    s_waitcnt lgkmcnt(7)
    v_mfma_f32_32x32x16_bf16 v[0:15], v[64:67], v[128:131], 0
    s_waitcnt lgkmcnt(6)
    v_mfma_f32_32x32x16_bf16 v[0:15], v[68:71], v[132:135], v[0:15]
    s_waitcnt lgkmcnt(5)
    v_mfma_f32_32x32x16_bf16 v[0:15], v[72:75], v[136:139], v[0:15]
    s_waitcnt lgkmcnt(4)
    v_mfma_f32_32x32x16_bf16 v[0:15], v[76:79], v[140:143], v[0:15]
    s_waitcnt lgkmcnt(3)
    v_mfma_f32_32x32x16_bf16 v[0:15], v[80:83], v[144:147], v[0:15]
    s_waitcnt lgkmcnt(2)
    v_mfma_f32_32x32x16_bf16 v[0:15], v[84:87], v[148:151], v[0:15]
    s_waitcnt lgkmcnt(1)
    v_mfma_f32_32x32x16_bf16 v[0:15], v[88:91], v[152:155], v[0:15]
    s_waitcnt lgkmcnt(0)
    v_mfma_f32_32x32x16_bf16 v[0:15], v[92:95], v[156:159], v[0:15]
    ds_read_b64_tr_b16 v[32:33], v174 offset:0
    ds_read_b64_tr_b16 v[34:35], v174 offset:2048
    ds_read_b64_tr_b16 v[36:37], v174 offset:4096
    ds_read_b64_tr_b16 v[38:39], v174 offset:6144
    ds_read_b64_tr_b16 v[40:41], v175 offset:0
    ds_read_b64_tr_b16 v[42:43], v175 offset:2048
    ds_read_b64_tr_b16 v[44:45], v175 offset:4096
    ds_read_b64_tr_b16 v[46:47], v175 offset:6144
    ds_read_b64_tr_b16 v[48:49], v176 offset:0
    ds_read_b64_tr_b16 v[50:51], v176 offset:2048
    ds_read_b64_tr_b16 v[52:53], v176 offset:4096
    ds_read_b64_tr_b16 v[54:55], v176 offset:6144
    ds_read_b64_tr_b16 v[56:57], v177 offset:0
    ds_read_b64_tr_b16 v[58:59], v177 offset:2048
    ds_read_b64_tr_b16 v[60:61], v177 offset:4096
    ds_read_b64_tr_b16 v[62:63], v177 offset:6144
    v_cvt_pk_bf16_f32 v16, v0, v1
    v_cvt_pk_bf16_f32 v17, v2, v3
    v_cvt_pk_bf16_f32 v18, v4, v5
    v_cvt_pk_bf16_f32 v19, v6, v7
    v_cvt_pk_bf16_f32 v20, v8, v9
    v_cvt_pk_bf16_f32 v21, v10, v11
    v_cvt_pk_bf16_f32 v22, v12, v13
    v_cvt_pk_bf16_f32 v23, v14, v15
    v_lshlrev_b32 v96, 16, v16
    v_and_b32 v97, 0xffff0000, v16
    v_lshlrev_b32 v98, 16, v17
    v_and_b32 v99, 0xffff0000, v17
    v_lshlrev_b32 v100, 16, v18
    v_and_b32 v101, 0xffff0000, v18
    v_lshlrev_b32 v102, 16, v19
    v_and_b32 v103, 0xffff0000, v19
    v_lshlrev_b32 v104, 16, v20
    v_and_b32 v105, 0xffff0000, v20
    v_lshlrev_b32 v106, 16, v21
    v_and_b32 v107, 0xffff0000, v21
    v_lshlrev_b32 v108, 16, v22
    v_and_b32 v109, 0xffff0000, v22
    v_lshlrev_b32 v110, 16, v23
    v_and_b32 v111, 0xffff0000, v23
    v_mul_f32 v96, s78, v96
    v_mul_f32 v97, s78, v97
    v_mul_f32 v98, s78, v98
    v_mul_f32 v99, s78, v99
    v_mul_f32 v100, s78, v100
    v_mul_f32 v101, s78, v101
    v_mul_f32 v102, s78, v102
    v_mul_f32 v103, s78, v103
    v_mul_f32 v104, s78, v104
    v_mul_f32 v105, s78, v105
    v_mul_f32 v106, s78, v106
    v_mul_f32 v107, s78, v107
    v_mul_f32 v108, s78, v108
    v_mul_f32 v109, s78, v109
    v_mul_f32 v110, s78, v110
    v_mul_f32 v111, s78, v111
    v_cvt_pk_bf16_f32 v16, v96, v97
    v_cvt_pk_bf16_f32 v17, v98, v99
    v_cvt_pk_bf16_f32 v18, v100, v101
    v_cvt_pk_bf16_f32 v19, v102, v103
    v_cvt_pk_bf16_f32 v20, v104, v105
    v_cvt_pk_bf16_f32 v21, v106, v107
    v_cvt_pk_bf16_f32 v22, v108, v109
    v_cvt_pk_bf16_f32 v23, v110, v111
    v_lshlrev_b32 v96, 16, v16
    v_and_b32 v97, 0xffff0000, v16
    v_lshlrev_b32 v98, 16, v17
    v_and_b32 v99, 0xffff0000, v17
    v_lshlrev_b32 v100, 16, v18
    v_and_b32 v101, 0xffff0000, v18
    v_lshlrev_b32 v102, 16, v19
    v_and_b32 v103, 0xffff0000, v19
    v_lshlrev_b32 v104, 16, v20
    v_and_b32 v105, 0xffff0000, v20
    v_lshlrev_b32 v106, 16, v21
    v_and_b32 v107, 0xffff0000, v21
    v_lshlrev_b32 v108, 16, v22
    v_and_b32 v109, 0xffff0000, v22
    v_lshlrev_b32 v110, 16, v23
    v_and_b32 v111, 0xffff0000, v23
    v_max3_f32 v190, v96, v97, v98
    v_max3_f32 v190, v190, v99, v100
    v_max3_f32 v190, v190, v101, v102
    v_max3_f32 v190, v190, v103, v104
    v_max3_f32 v190, v190, v105, v106
    v_max3_f32 v190, v190, v107, v108
    v_max3_f32 v190, v190, v109, v110
    v_max_f32 v190, v190, v111
    v_mov_b32 v191, v190
    s_nop 1
    v_permlane32_swap_b32 v190, v191
    s_nop 1
    v_max_f32 v190, v190, v191
    v_mul_f32 v190, s79, v190
    v_fma_f32 v96, v96, s79, -v190
    v_fma_f32 v97, v97, s79, -v190
    v_fma_f32 v98, v98, s79, -v190
    v_fma_f32 v99, v99, s79, -v190
    v_fma_f32 v100, v100, s79, -v190
    v_fma_f32 v101, v101, s79, -v190
    v_fma_f32 v102, v102, s79, -v190
    v_fma_f32 v103, v103, s79, -v190
    v_fma_f32 v104, v104, s79, -v190
    v_fma_f32 v105, v105, s79, -v190
    v_fma_f32 v106, v106, s79, -v190
    v_fma_f32 v107, v107, s79, -v190
    v_fma_f32 v108, v108, s79, -v190
    v_fma_f32 v109, v109, s79, -v190
    v_fma_f32 v110, v110, s79, -v190
    v_fma_f32 v111, v111, s79, -v190
    v_exp_f32 v96, v96
    v_exp_f32 v97, v97
    v_exp_f32 v98, v98
    v_exp_f32 v99, v99
    v_exp_f32 v100, v100
    v_exp_f32 v101, v101
    v_exp_f32 v102, v102
    v_exp_f32 v103, v103
    v_exp_f32 v104, v104
    v_exp_f32 v105, v105
    v_exp_f32 v106, v106
    v_exp_f32 v107, v107
    v_exp_f32 v108, v108
    v_exp_f32 v109, v109
    v_exp_f32 v110, v110
    v_exp_f32 v111, v111
    s_nop 0
    v_add_f32 v192, v96, v97
    v_add_f32 v193, v98, v99
    v_add_f32 v192, v192, v100
    v_add_f32 v193, v193, v101
    v_add_f32 v192, v192, v102
    v_add_f32 v193, v193, v103
    v_add_f32 v192, v192, v104
    v_add_f32 v193, v193, v105
    v_add_f32 v192, v192, v106
    v_add_f32 v193, v193, v107
    v_add_f32 v192, v192, v108
    v_add_f32 v193, v193, v109
    v_add_f32 v192, v192, v110
    v_add_f32 v193, v193, v111
    v_add_f32 v192, v192, v193
    v_mov_b32 v193, v192
    s_nop 1
    v_permlane32_swap_b32 v192, v193
    s_nop 1
    v_add_f32 v192, v192, v193
    v_rcp_f32 v192, v192
    s_nop 0
    v_mul_f32 v96, v96, v192
    v_mul_f32 v97, v97, v192
    v_mul_f32 v98, v98, v192
    v_mul_f32 v99, v99, v192
    v_mul_f32 v100, v100, v192
    v_mul_f32 v101, v101, v192
    v_mul_f32 v102, v102, v192
    v_mul_f32 v103, v103, v192
    v_mul_f32 v104, v104, v192
    v_mul_f32 v105, v105, v192
    v_mul_f32 v106, v106, v192
    v_mul_f32 v107, v107, v192
    v_mul_f32 v108, v108, v192
    v_mul_f32 v109, v109, v192
    v_mul_f32 v110, v110, v192
    v_mul_f32 v111, v111, v192
    v_cvt_pk_bf16_f32 v16, v96, v97
    v_cvt_pk_bf16_f32 v17, v98, v99
    v_cvt_pk_bf16_f32 v18, v100, v101
    v_cvt_pk_bf16_f32 v19, v102, v103
    v_cvt_pk_bf16_f32 v20, v104, v105
    v_cvt_pk_bf16_f32 v21, v106, v107
    v_cvt_pk_bf16_f32 v22, v108, v109
    v_cvt_pk_bf16_f32 v23, v110, v111
    s_waitcnt lgkmcnt(0)
    s_nop 1
    v_mfma_f32_32x32x16_bf16 v[64:79], v[32:35], v[16:19], 0
    v_mfma_f32_32x32x16_bf16 v[64:79], v[36:39], v[20:23], v[64:79]
    v_mfma_f32_32x32x16_bf16 v[80:95], v[40:43], v[16:19], 0
    v_mfma_f32_32x32x16_bf16 v[80:95], v[44:47], v[20:23], v[80:95]
    v_mfma_f32_32x32x16_bf16 v[96:111], v[48:51], v[16:19], 0
    v_mfma_f32_32x32x16_bf16 v[96:111], v[52:55], v[20:23], v[96:111]
    v_mfma_f32_32x32x16_bf16 v[112:127], v[56:59], v[16:19], 0
    v_mfma_f32_32x32x16_bf16 v[112:127], v[60:63], v[20:23], v[112:127]
    v_lshrrev_b32 v190, 4, v200
    v_and_b32 v191, 15, v200
    v_lshlrev_b32 v190, 13, v190
    v_lshl_add_u32 v190, v191, 4, v190
    s_lshl_b32 s69, s65, 18
    s_lshl_b32 s70, s66, 8
    s_add_u32 s69, s69, s70
    s_nop 7
    s_nop 3
    v_cvt_pk_bf16_f32 v128, v64, v65
    v_cvt_pk_bf16_f32 v129, v66, v67
    v_cvt_pk_bf16_f32 v130, v68, v69
    v_cvt_pk_bf16_f32 v131, v70, v71
    v_xor_b32 v199, 0, v196
    ds_write_b128 v199, v[128:131]
    v_cvt_pk_bf16_f32 v132, v72, v73
    v_cvt_pk_bf16_f32 v133, v74, v75
    v_cvt_pk_bf16_f32 v134, v76, v77
    v_cvt_pk_bf16_f32 v135, v78, v79
    v_xor_b32 v199, 32, v196
    ds_write_b128 v199, v[132:135]
    v_cvt_pk_bf16_f32 v136, v80, v81
    v_cvt_pk_bf16_f32 v137, v82, v83
    v_cvt_pk_bf16_f32 v138, v84, v85
    v_cvt_pk_bf16_f32 v139, v86, v87
    v_xor_b32 v199, 64, v196
    ds_write_b128 v199, v[136:139]
    v_cvt_pk_bf16_f32 v140, v88, v89
    v_cvt_pk_bf16_f32 v141, v90, v91
    v_cvt_pk_bf16_f32 v142, v92, v93
    v_cvt_pk_bf16_f32 v143, v94, v95
    v_xor_b32 v199, 96, v196
    ds_write_b128 v199, v[140:143]
    v_cvt_pk_bf16_f32 v144, v96, v97
    v_cvt_pk_bf16_f32 v145, v98, v99
    v_cvt_pk_bf16_f32 v146, v100, v101
    v_cvt_pk_bf16_f32 v147, v102, v103
    v_xor_b32 v199, 128, v196
    ds_write_b128 v199, v[144:147]
    v_cvt_pk_bf16_f32 v148, v104, v105
    v_cvt_pk_bf16_f32 v149, v106, v107
    v_cvt_pk_bf16_f32 v150, v108, v109
    v_cvt_pk_bf16_f32 v151, v110, v111
    v_xor_b32 v199, 160, v196
    ds_write_b128 v199, v[148:151]
    v_cvt_pk_bf16_f32 v152, v112, v113
    v_cvt_pk_bf16_f32 v153, v114, v115
    v_cvt_pk_bf16_f32 v154, v116, v117
    v_cvt_pk_bf16_f32 v155, v118, v119
    v_xor_b32 v199, 192, v196
    ds_write_b128 v199, v[152:155]
    v_cvt_pk_bf16_f32 v156, v120, v121
    v_cvt_pk_bf16_f32 v157, v122, v123
    v_cvt_pk_bf16_f32 v158, v124, v125
    v_cvt_pk_bf16_f32 v159, v126, v127
    v_xor_b32 v199, 224, v196
    ds_write_b128 v199, v[156:159]
    s_waitcnt lgkmcnt(0)
    v_xor_b32 v199, 0, v198
    ds_read_b128 v[64:67], v199 offset:0
    v_xor_b32 v199, 64, v198
    ds_read_b128 v[68:71], v199 offset:1024
    v_xor_b32 v199, 128, v198
    ds_read_b128 v[72:75], v199 offset:2048
    v_xor_b32 v199, 192, v198
    ds_read_b128 v[76:79], v199 offset:3072
    v_xor_b32 v199, 0, v198
    ds_read_b128 v[80:83], v199 offset:4096
    v_xor_b32 v199, 64, v198
    ds_read_b128 v[84:87], v199 offset:5120
    v_xor_b32 v199, 128, v198
    ds_read_b128 v[88:91], v199 offset:6144
    v_xor_b32 v199, 192, v198
    ds_read_b128 v[92:95], v199 offset:7168
    s_add_u32 s70, s69, 0
    s_waitcnt lgkmcnt(7)
    buffer_store_dwordx4 v[64:67], v190, s[56:59], s70 offen
    s_add_u32 s70, s69, 32768
    s_waitcnt lgkmcnt(6)
    buffer_store_dwordx4 v[68:71], v190, s[56:59], s70 offen
    s_add_u32 s70, s69, 65536
    s_waitcnt lgkmcnt(5)
    buffer_store_dwordx4 v[72:75], v190, s[56:59], s70 offen
    s_add_u32 s70, s69, 98304
    s_waitcnt lgkmcnt(4)
    buffer_store_dwordx4 v[76:79], v190, s[56:59], s70 offen
    s_add_u32 s70, s69, 131072
    s_waitcnt lgkmcnt(3)
    buffer_store_dwordx4 v[80:83], v190, s[56:59], s70 offen
    s_add_u32 s70, s69, 163840
    s_waitcnt lgkmcnt(2)
    buffer_store_dwordx4 v[84:87], v190, s[56:59], s70 offen
    s_add_u32 s70, s69, 196608
    s_waitcnt lgkmcnt(1)
    buffer_store_dwordx4 v[88:91], v190, s[56:59], s70 offen
    s_add_u32 s70, s69, 229376
    s_waitcnt lgkmcnt(0)
    buffer_store_dwordx4 v[92:95], v190, s[56:59], s70 offen
    s_waitcnt vmcnt(0)
    s_barrier
    s_lshl_b32 s70, s80, 23
    s_add_u32 s70, s70, 0x1000000
    s_add_u32 s36, s30, s70
    s_addc_u32 s37, s31, 0
    s_mov_b32 s52, s36
    s_and_b32 s53, s37, 0xffff
    s_mov_b32 s54, 0x800000
    s_mov_b32 s55, 0x00020000
    s_lshr_b32 s61, s60, 2
    s_bfe_u32 s62, s60, 0x10001
    s_and_b32 s65, s60, 1
    s_lshl_b32 s64, s39, 2
    s_lshl_b32 s78, s81, 11
    s_lshl_b32 s79, s81, 20
    v_lshrrev_b32 v190, 3, v200
    v_and_b32 v191, 7, v200
    v_lshrrev_b32 v192, 1, v190
    s_lshl_b32 s70, s63, 7
    s_lshl_b32 s71, s60, 4
    s_add_u32 s70, s70, s71
    v_add_u32 v193, 0, v192
    v_xor_b32 v193, v193, v191
    v_add_u32 v194, s70, v190
    v_add_u32 v194, 0, v194
    v_lshlrev_b32 v194, 13, v194
    v_lshl_add_u32 v114, v193, 4, v194
    v_add_u32 v193, 4, v192
    v_xor_b32 v193, v193, v191
    v_add_u32 v194, s70, v190
    v_add_u32 v194, 8, v194
    v_lshlrev_b32 v194, 13, v194
    v_lshl_add_u32 v115, v193, 4, v194
    v_lshrrev_b32 v190, 4, v200
    v_and_b32 v191, 15, v200
    v_lshlrev_b32 v192, 2, v190
    v_xor_b32 v191, v191, v192
    s_lshl_b32 s70, s60, 3
    v_add_u32 v190, s70, v190
    v_lshlrev_b32 v190, 10, v190
    v_lshl_add_u32 v190, v191, 4, v190
    s_lshl_b32 s71, s39, 8
    v_add_u32 v116, s71, v190
    s_lshl_b32 s74, s60, 11
    s_add_u32 s75, s74, 16384
    s_add_u32 s36, s30, 0x3000000
    s_addc_u32 s37, s31, 0
    s_mov_b32 s48, s36
    s_and_b32 s49, s37, 0xffff
    s_mov_b32 s50, 0x4000
    s_mov_b32 s51, 0x00020000
    s_cmp_lg_u32 s60, 0
    s_cbranch_scc1 F_S1_SKIP
    v_readfirstlane_b32 s68, v212
    s_and_b32 s70, s2, 7
    s_lshl_b32 s67, s70, 3
    s_add_u32 s67, s67, s63
    s_lshl_b32 s67, s67, 7
    s_cmp_eq_u32 s68, 0
    s_cselect_b32 s68, s8, s68
    s_lshl_b32 s3, s3, 1
    s_add_u32 s68, s68, s3
    s_getreg_b32 s12, hwreg(HW_REG_XCC_ID)
    s_and_b32 s12, s12, 7
    s_lshl_b32 s70, s39, 3
    s_add_u32 s70, s70, s67
    v_mov_b32 v190, s70
    v_mov_b32 v192, s68
    v_mov_b32 v193, s12
    v_cmp_eq_u32 vcc, 0, v200
    s_and_saveexec_b64 s[10:11], vcc
    buffer_store_dwordx2 v[192:193], v190, s[48:51], 0 offen offset:0 sc0 sc1
    s_mov_b64 exec, s[10:11]
F_S1_SKIP:
    s_add_u32 s73, s64, 0
    s_and_b32 s73, s73, 15
    s_lshl_b32 s76, s73, 7
    s_add_u32 s76, s76, s78
    s_lshl_b32 s73, s73, 16
    s_add_u32 s73, s73, s79
    s_add_u32 m0, s74, 0
    s_nop 0
    buffer_load_dwordx4 v114, s[56:59], s76 offen lds
    s_add_u32 m0, s74, 1024
    s_nop 0
    buffer_load_dwordx4 v115, s[56:59], s76 offen lds
    s_add_u32 s77, s73, 0
    s_add_u32 m0, s75, 0
    s_nop 0
    buffer_load_dwordx4 v116, s[44:47], s77 offen lds
    s_add_u32 s77, s73, 4096
    s_add_u32 m0, s75, 1024
    s_nop 0
    buffer_load_dwordx4 v116, s[44:47], s77 offen lds
    s_add_u32 s73, s64, 1
    s_and_b32 s73, s73, 15
    s_lshl_b32 s76, s73, 7
    s_add_u32 s76, s76, s78
    s_lshl_b32 s73, s73, 16
    s_add_u32 s73, s73, s79
    s_add_u32 m0, s74, 32768
    s_nop 0
    buffer_load_dwordx4 v114, s[56:59], s76 offen lds
    s_add_u32 m0, s74, 33792
    s_nop 0
    buffer_load_dwordx4 v115, s[56:59], s76 offen lds
    s_add_u32 s77, s73, 0
    s_add_u32 m0, s75, 32768
    s_nop 0
    buffer_load_dwordx4 v116, s[44:47], s77 offen lds
    s_add_u32 s77, s73, 4096
    s_add_u32 m0, s75, 33792
    s_nop 0
    buffer_load_dwordx4 v116, s[44:47], s77 offen lds
    v_and_b32 v190, 31, v200
    v_lshrrev_b32 v191, 5, v200
    v_bfe_u32 v192, v190, 1, 3
    s_lshl_b32 s70, s62, 6
    v_add_u32 v193, s70, v190
    v_lshlrev_b32 v193, 7, v193
    s_lshl_b32 s71, s61, 2
    v_add_u32 v194, s71, v191
    v_add_u32 v194, 0, v194
    v_xor_b32 v194, v194, v192
    v_lshl_add_u32 v96, v194, 4, v193
    v_add_u32 v97, 4096, v96
    v_add_u32 v194, s71, v191
    v_add_u32 v194, 2, v194
    v_xor_b32 v194, v194, v192
    v_lshl_add_u32 v98, v194, 4, v193
    v_add_u32 v99, 4096, v98
    v_lshrrev_b32 v190, 4, v200
    v_and_b32 v191, 1, v190
    v_lshrrev_b32 v190, 1, v190
    v_bfe_u32 v192, v200, 2, 2
    v_and_b32 v193, 1, v200
    v_bfe_u32 v194, v200, 1, 1
    v_lshl_add_u32 v193, v193, 1, v194
    v_lshlrev_b32 v193, 3, v193
    v_lshl_add_u32 v193, v191, 5, v193
    v_lshl_add_u32 v194, v190, 3, v192
    s_lshl_b32 s70, s61, 5
    v_add_u32 v194, s70, v194
    v_lshl_add_u32 v194, v194, 8, v193
    v_add_u32 v194, 16384, v194
    s_lshl_b32 s71, s65, 1
    s_add_u32 s72, s71, 0
    v_xor_b32 v191, s72, v192
    v_lshl_add_u32 v108, v191, 6, v194
    s_add_u32 s72, s71, 1
    v_xor_b32 v191, s72, v192
    v_lshl_add_u32 v109, v191, 6, v194
    v_add_u32 v100, 0x10000, v96
    v_add_u32 v101, 0x10000, v97
    v_add_u32 v102, 0x10000, v98
    v_add_u32 v103, 0x10000, v99
    v_add_u32 v110, 0x10000, v108
    v_add_u32 v111, 0x10000, v109
    v_add_u32 v104, 0x20000, v96
    v_add_u32 v105, 0x20000, v97
    v_add_u32 v106, 0x20000, v98
    v_add_u32 v107, 0x20000, v99
    v_add_u32 v112, 0x20000, v108
    v_add_u32 v113, 0x20000, v109
    v_mov_b32 v0, 0
    v_mov_b32 v1, 0
    v_mov_b32 v2, 0
    v_mov_b32 v3, 0
    v_mov_b32 v4, 0
    v_mov_b32 v5, 0
    v_mov_b32 v6, 0
    v_mov_b32 v7, 0
    v_mov_b32 v8, 0
    v_mov_b32 v9, 0
    v_mov_b32 v10, 0
    v_mov_b32 v11, 0
    v_mov_b32 v12, 0
    v_mov_b32 v13, 0
    v_mov_b32 v14, 0
    v_mov_b32 v15, 0
    v_mov_b32 v16, 0
    v_mov_b32 v17, 0
    v_mov_b32 v18, 0
    v_mov_b32 v19, 0
    v_mov_b32 v20, 0
    v_mov_b32 v21, 0
    v_mov_b32 v22, 0
    v_mov_b32 v23, 0
    v_mov_b32 v24, 0
    v_mov_b32 v25, 0
    v_mov_b32 v26, 0
    v_mov_b32 v27, 0
    v_mov_b32 v28, 0
    v_mov_b32 v29, 0
    v_mov_b32 v30, 0
    v_mov_b32 v31, 0
    v_mov_b32 v32, 0
    v_mov_b32 v33, 0
    v_mov_b32 v34, 0
    v_mov_b32 v35, 0
    v_mov_b32 v36, 0
    v_mov_b32 v37, 0
    v_mov_b32 v38, 0
    v_mov_b32 v39, 0
    v_mov_b32 v40, 0
    v_mov_b32 v41, 0
    v_mov_b32 v42, 0
    v_mov_b32 v43, 0
    v_mov_b32 v44, 0
    v_mov_b32 v45, 0
    v_mov_b32 v46, 0
    v_mov_b32 v47, 0
    v_mov_b32 v48, 0
    v_mov_b32 v49, 0
    v_mov_b32 v50, 0
    v_mov_b32 v51, 0
    v_mov_b32 v52, 0
    v_mov_b32 v53, 0
    v_mov_b32 v54, 0
    v_mov_b32 v55, 0
    v_mov_b32 v56, 0
    v_mov_b32 v57, 0
    v_mov_b32 v58, 0
    v_mov_b32 v59, 0
    v_mov_b32 v60, 0
    v_mov_b32 v61, 0
    v_mov_b32 v62, 0
    v_mov_b32 v63, 0
    s_waitcnt vmcnt(4)
    s_barrier
    ds_read_b128 v[64:67], v96 offset:0
    ds_read_b128 v[68:71], v97 offset:0
    ds_read_b64_tr_b16 v[80:81], v108 offset:0
    ds_read_b64_tr_b16 v[82:83], v108 offset:1024
    ds_read_b64_tr_b16 v[84:85], v109 offset:0
    ds_read_b64_tr_b16 v[86:87], v109 offset:1024
    s_add_u32 s73, s64, 2
    s_and_b32 s73, s73, 15
    s_lshl_b32 s76, s73, 7
    s_add_u32 s76, s76, s78
    s_lshl_b32 s73, s73, 16
    s_add_u32 s73, s73, s79
    s_add_u32 m0, s74, 65536
    s_nop 0
    buffer_load_dwordx4 v114, s[56:59], s76 offen lds
    s_add_u32 m0, s74, 66560
    s_nop 0
    buffer_load_dwordx4 v115, s[56:59], s76 offen lds
    s_add_u32 s77, s73, 0
    s_add_u32 m0, s75, 65536
    s_nop 0
    buffer_load_dwordx4 v116, s[44:47], s77 offen lds
    s_add_u32 s77, s73, 4096
    s_add_u32 m0, s75, 66560
    s_nop 0
    buffer_load_dwordx4 v116, s[44:47], s77 offen lds
    s_add_u32 s73, s64, 3
    s_and_b32 s73, s73, 15
    s_lshl_b32 s76, s73, 7
    s_add_u32 s76, s76, s78
    s_lshl_b32 s73, s73, 16
    s_add_u32 s73, s73, s79
    s_add_u32 m0, s74, 98304
    s_nop 0
    buffer_load_dwordx4 v114, s[56:59], s76 offen lds
    s_add_u32 m0, s74, 99328
    s_nop 0
    buffer_load_dwordx4 v115, s[56:59], s76 offen lds
    s_add_u32 s77, s73, 0
    s_add_u32 m0, s75, 98304
    s_nop 0
    buffer_load_dwordx4 v116, s[44:47], s77 offen lds
    s_add_u32 s77, s73, 4096
    s_add_u32 m0, s75, 99328
    s_nop 0
    buffer_load_dwordx4 v116, s[44:47], s77 offen lds
    ds_read_b128 v[72:75], v98 offset:0
    ds_read_b128 v[76:79], v99 offset:0
    ds_read_b64_tr_b16 v[88:89], v108 offset:4096
    ds_read_b64_tr_b16 v[90:91], v108 offset:5120
    ds_read_b64_tr_b16 v[92:93], v109 offset:4096
    ds_read_b64_tr_b16 v[94:95], v109 offset:5120
    s_waitcnt lgkmcnt(8)
    v_mfma_f32_32x32x16_bf16 v[0:15], v[80:83], v[64:67], v[0:15]
    v_mfma_f32_32x32x16_bf16 v[32:47], v[80:83], v[68:71], v[32:47]
    s_waitcnt lgkmcnt(6)
    v_mfma_f32_32x32x16_bf16 v[16:31], v[84:87], v[64:67], v[16:31]
    v_mfma_f32_32x32x16_bf16 v[48:63], v[84:87], v[68:71], v[48:63]
    s_waitcnt lgkmcnt(0)
    s_waitcnt vmcnt(8)
    s_barrier
    ds_read_b128 v[64:67], v96 offset:32768
    ds_read_b128 v[68:71], v97 offset:32768
    ds_read_b64_tr_b16 v[80:81], v108 offset:32768
    ds_read_b64_tr_b16 v[82:83], v108 offset:33792
    ds_read_b64_tr_b16 v[84:85], v109 offset:32768
    ds_read_b64_tr_b16 v[86:87], v109 offset:33792
    v_mfma_f32_32x32x16_bf16 v[0:15], v[88:91], v[72:75], v[0:15]
    v_mfma_f32_32x32x16_bf16 v[32:47], v[88:91], v[76:79], v[32:47]
    v_mfma_f32_32x32x16_bf16 v[16:31], v[92:95], v[72:75], v[16:31]
    v_mfma_f32_32x32x16_bf16 v[48:63], v[92:95], v[76:79], v[48:63]
    ds_read_b128 v[72:75], v98 offset:32768
    ds_read_b128 v[76:79], v99 offset:32768
    ds_read_b64_tr_b16 v[88:89], v108 offset:36864
    ds_read_b64_tr_b16 v[90:91], v108 offset:37888
    ds_read_b64_tr_b16 v[92:93], v109 offset:36864
    ds_read_b64_tr_b16 v[94:95], v109 offset:37888
    s_waitcnt lgkmcnt(8)
    v_mfma_f32_32x32x16_bf16 v[0:15], v[80:83], v[64:67], v[0:15]
    v_mfma_f32_32x32x16_bf16 v[32:47], v[80:83], v[68:71], v[32:47]
    s_waitcnt lgkmcnt(6)
    v_mfma_f32_32x32x16_bf16 v[16:31], v[84:87], v[64:67], v[16:31]
    v_mfma_f32_32x32x16_bf16 v[48:63], v[84:87], v[68:71], v[48:63]
    s_waitcnt lgkmcnt(0)
    s_cmp_lg_u32 s60, 0
    s_cbranch_scc1 F_S1_DONE
    v_and_b32 v190, 3, v200
    v_lshlrev_b32 v190, 3, v190
    v_add_u32 v190, s67, v190
    s_mov_b32 s69, 0
F_S1A_POLL:
    buffer_load_dwordx2 v[192:193], v190, s[48:51], 0 offen offset:0 sc0 sc1
    s_waitcnt vmcnt(0)
    v_cmp_ne_u32 vcc, s68, v192
    s_nop 3
    s_cmp_eq_u64 vcc, 0
    s_cbranch_scc1 F_S1A_OK
    s_sleep 2
    s_add_u32 s69, s69, 1
    s_cmp_lt_u32 s69, 200000
    s_cbranch_scc1 F_S1A_POLL
F_S1A_OK:
    v_cmp_ne_u32 vcc, s12, v193
    s_nop 3
    s_cmp_eq_u64 vcc, 0
    s_cbranch_scc1 F_S1_DONE
    buffer_wbl2 sc1
    s_waitcnt vmcnt(0)
    s_lshl_b32 s70, s39, 3
    s_add_u32 s70, s70, s67
    v_mov_b32 v190, s70
    v_mov_b32 v192, s68
    v_mov_b32 v193, s12
    v_cmp_eq_u32 vcc, 0, v200
    s_and_saveexec_b64 s[10:11], vcc
    buffer_store_dwordx2 v[192:193], v190, s[48:51], 0 offen offset:64 sc0 sc1
    s_mov_b64 exec, s[10:11]
    v_and_b32 v190, 3, v200
    v_lshlrev_b32 v190, 3, v190
    v_add_u32 v190, s67, v190
    s_mov_b32 s69, 0
F_S1B_POLL:
    buffer_load_dwordx2 v[192:193], v190, s[48:51], 0 offen offset:64 sc0 sc1
    s_waitcnt vmcnt(0)
    v_cmp_ne_u32 vcc, s68, v192
    s_nop 3
    s_cmp_eq_u64 vcc, 0
    s_cbranch_scc1 F_S1B_OK
    s_sleep 2
    s_add_u32 s69, s69, 1
    s_cmp_lt_u32 s69, 200000
    s_cbranch_scc1 F_S1B_POLL
F_S1B_OK:
    buffer_inv sc1
    s_waitcnt vmcnt(0)
F_S1_DONE:
    s_waitcnt vmcnt(4)
    s_barrier
    ds_read_b128 v[64:67], v100 offset:0
    ds_read_b128 v[68:71], v101 offset:0
    ds_read_b64_tr_b16 v[80:81], v110 offset:0
    ds_read_b64_tr_b16 v[82:83], v110 offset:1024
    ds_read_b64_tr_b16 v[84:85], v111 offset:0
    ds_read_b64_tr_b16 v[86:87], v111 offset:1024
    v_mfma_f32_32x32x16_bf16 v[0:15], v[88:91], v[72:75], v[0:15]
    s_add_u32 s73, s64, 4
    s_and_b32 s73, s73, 15
    s_lshl_b32 s76, s73, 7
    s_add_u32 s76, s76, s78
    s_lshl_b32 s73, s73, 16
    s_add_u32 s73, s73, s79
    s_add_u32 m0, s74, 131072
    s_nop 0
    buffer_load_dwordx4 v114, s[56:59], s76 offen lds
    s_add_u32 m0, s74, 132096
    s_nop 0
    buffer_load_dwordx4 v115, s[56:59], s76 offen lds
    v_mfma_f32_32x32x16_bf16 v[32:47], v[88:91], v[76:79], v[32:47]
    s_add_u32 s77, s73, 0
    s_add_u32 m0, s75, 131072
    s_nop 0
    buffer_load_dwordx4 v116, s[44:47], s77 offen lds
    s_add_u32 s77, s73, 4096
    s_add_u32 m0, s75, 132096
    s_nop 0
    buffer_load_dwordx4 v116, s[44:47], s77 offen lds
    v_mfma_f32_32x32x16_bf16 v[16:31], v[92:95], v[72:75], v[16:31]
    s_add_u32 s73, s64, 5
    s_and_b32 s73, s73, 15
    s_lshl_b32 s76, s73, 7
    s_add_u32 s76, s76, s78
    s_lshl_b32 s73, s73, 16
    s_add_u32 s73, s73, s79
    s_add_u32 m0, s74, 0
    s_nop 0
    buffer_load_dwordx4 v114, s[56:59], s76 offen lds
    s_add_u32 m0, s74, 1024
    s_nop 0
    buffer_load_dwordx4 v115, s[56:59], s76 offen lds
    v_mfma_f32_32x32x16_bf16 v[48:63], v[92:95], v[76:79], v[48:63]
    s_add_u32 s77, s73, 0
    s_add_u32 m0, s75, 0
    s_nop 0
    buffer_load_dwordx4 v116, s[44:47], s77 offen lds
    s_add_u32 s77, s73, 4096
    s_add_u32 m0, s75, 1024
    s_nop 0
    buffer_load_dwordx4 v116, s[44:47], s77 offen lds
    ds_read_b128 v[72:75], v102 offset:0
    ds_read_b128 v[76:79], v103 offset:0
    ds_read_b64_tr_b16 v[88:89], v110 offset:4096
    ds_read_b64_tr_b16 v[90:91], v110 offset:5120
    ds_read_b64_tr_b16 v[92:93], v111 offset:4096
    ds_read_b64_tr_b16 v[94:95], v111 offset:5120
    s_waitcnt lgkmcnt(8)
    v_mfma_f32_32x32x16_bf16 v[0:15], v[80:83], v[64:67], v[0:15]
    v_mfma_f32_32x32x16_bf16 v[32:47], v[80:83], v[68:71], v[32:47]
    s_waitcnt lgkmcnt(6)
    v_mfma_f32_32x32x16_bf16 v[16:31], v[84:87], v[64:67], v[16:31]
    v_mfma_f32_32x32x16_bf16 v[48:63], v[84:87], v[68:71], v[48:63]
    s_waitcnt lgkmcnt(0)
    s_waitcnt vmcnt(8)
    s_barrier
    ds_read_b128 v[64:67], v100 offset:32768
    ds_read_b128 v[68:71], v101 offset:32768
    ds_read_b64_tr_b16 v[80:81], v110 offset:32768
    ds_read_b64_tr_b16 v[82:83], v110 offset:33792
    ds_read_b64_tr_b16 v[84:85], v111 offset:32768
    ds_read_b64_tr_b16 v[86:87], v111 offset:33792
    v_mfma_f32_32x32x16_bf16 v[0:15], v[88:91], v[72:75], v[0:15]
    s_add_u32 s73, s64, 6
    s_and_b32 s73, s73, 15
    s_lshl_b32 s76, s73, 7
    s_add_u32 s76, s76, s78
    s_lshl_b32 s73, s73, 16
    s_add_u32 s73, s73, s79
    s_add_u32 m0, s74, 32768
    s_nop 0
    buffer_load_dwordx4 v114, s[56:59], s76 offen lds
    s_add_u32 m0, s74, 33792
    s_nop 0
    buffer_load_dwordx4 v115, s[56:59], s76 offen lds
    v_mfma_f32_32x32x16_bf16 v[32:47], v[88:91], v[76:79], v[32:47]
    s_add_u32 s77, s73, 0
    s_add_u32 m0, s75, 32768
    s_nop 0
    buffer_load_dwordx4 v116, s[44:47], s77 offen lds
    s_add_u32 s77, s73, 4096
    s_add_u32 m0, s75, 33792
    s_nop 0
    buffer_load_dwordx4 v116, s[44:47], s77 offen lds
    v_mfma_f32_32x32x16_bf16 v[16:31], v[92:95], v[72:75], v[16:31]
    s_add_u32 s73, s64, 7
    s_and_b32 s73, s73, 15
    s_lshl_b32 s76, s73, 7
    s_add_u32 s76, s76, s78
    s_lshl_b32 s73, s73, 16
    s_add_u32 s73, s73, s79
    s_add_u32 m0, s74, 65536
    s_nop 0
    buffer_load_dwordx4 v114, s[56:59], s76 offen lds
    s_add_u32 m0, s74, 66560
    s_nop 0
    buffer_load_dwordx4 v115, s[56:59], s76 offen lds
    v_mfma_f32_32x32x16_bf16 v[48:63], v[92:95], v[76:79], v[48:63]
    s_add_u32 s77, s73, 0
    s_add_u32 m0, s75, 65536
    s_nop 0
    buffer_load_dwordx4 v116, s[44:47], s77 offen lds
    s_add_u32 s77, s73, 4096
    s_add_u32 m0, s75, 66560
    s_nop 0
    buffer_load_dwordx4 v116, s[44:47], s77 offen lds
    ds_read_b128 v[72:75], v102 offset:32768
    ds_read_b128 v[76:79], v103 offset:32768
    ds_read_b64_tr_b16 v[88:89], v110 offset:36864
    ds_read_b64_tr_b16 v[90:91], v110 offset:37888
    ds_read_b64_tr_b16 v[92:93], v111 offset:36864
    ds_read_b64_tr_b16 v[94:95], v111 offset:37888
    s_waitcnt lgkmcnt(8)
    v_mfma_f32_32x32x16_bf16 v[0:15], v[80:83], v[64:67], v[0:15]
    v_mfma_f32_32x32x16_bf16 v[32:47], v[80:83], v[68:71], v[32:47]
    s_waitcnt lgkmcnt(6)
    v_mfma_f32_32x32x16_bf16 v[16:31], v[84:87], v[64:67], v[16:31]
    v_mfma_f32_32x32x16_bf16 v[48:63], v[84:87], v[68:71], v[48:63]
    s_waitcnt lgkmcnt(0)
    s_waitcnt vmcnt(12)
    s_barrier
    ds_read_b128 v[64:67], v104 offset:0
    ds_read_b128 v[68:71], v105 offset:0
    ds_read_b64_tr_b16 v[80:81], v112 offset:0
    ds_read_b64_tr_b16 v[82:83], v112 offset:1024
    ds_read_b64_tr_b16 v[84:85], v113 offset:0
    ds_read_b64_tr_b16 v[86:87], v113 offset:1024
    v_mfma_f32_32x32x16_bf16 v[0:15], v[88:91], v[72:75], v[0:15]
    s_add_u32 s73, s64, 8
    s_and_b32 s73, s73, 15
    s_lshl_b32 s76, s73, 7
    s_add_u32 s76, s76, s78
    s_lshl_b32 s73, s73, 16
    s_add_u32 s73, s73, s79
    s_add_u32 m0, s74, 98304
    s_nop 0
    buffer_load_dwordx4 v114, s[56:59], s76 offen lds
    v_mfma_f32_32x32x16_bf16 v[32:47], v[88:91], v[76:79], v[32:47]
    s_add_u32 m0, s74, 99328
    s_nop 0
    buffer_load_dwordx4 v115, s[56:59], s76 offen lds
    v_mfma_f32_32x32x16_bf16 v[16:31], v[92:95], v[72:75], v[16:31]
    s_add_u32 s77, s73, 0
    s_add_u32 m0, s75, 98304
    s_nop 0
    buffer_load_dwordx4 v116, s[44:47], s77 offen lds
    v_mfma_f32_32x32x16_bf16 v[48:63], v[92:95], v[76:79], v[48:63]
    s_add_u32 s77, s73, 4096
    s_add_u32 m0, s75, 99328
    s_nop 0
    buffer_load_dwordx4 v116, s[44:47], s77 offen lds
    ds_read_b128 v[72:75], v106 offset:0
    ds_read_b128 v[76:79], v107 offset:0
    ds_read_b64_tr_b16 v[88:89], v112 offset:4096
    ds_read_b64_tr_b16 v[90:91], v112 offset:5120
    ds_read_b64_tr_b16 v[92:93], v113 offset:4096
    ds_read_b64_tr_b16 v[94:95], v113 offset:5120
    s_waitcnt lgkmcnt(8)
    v_mfma_f32_32x32x16_bf16 v[0:15], v[80:83], v[64:67], v[0:15]
    v_mfma_f32_32x32x16_bf16 v[32:47], v[80:83], v[68:71], v[32:47]
    s_waitcnt lgkmcnt(6)
    v_mfma_f32_32x32x16_bf16 v[16:31], v[84:87], v[64:67], v[16:31]
    v_mfma_f32_32x32x16_bf16 v[48:63], v[84:87], v[68:71], v[48:63]
    s_waitcnt lgkmcnt(0)
    s_waitcnt vmcnt(12)
    s_barrier
    ds_read_b128 v[64:67], v96 offset:0
    ds_read_b128 v[68:71], v97 offset:0
    ds_read_b64_tr_b16 v[80:81], v108 offset:0
    ds_read_b64_tr_b16 v[82:83], v108 offset:1024
    ds_read_b64_tr_b16 v[84:85], v109 offset:0
    ds_read_b64_tr_b16 v[86:87], v109 offset:1024
    v_mfma_f32_32x32x16_bf16 v[0:15], v[88:91], v[72:75], v[0:15]
    s_add_u32 s73, s64, 9
    s_and_b32 s73, s73, 15
    s_lshl_b32 s76, s73, 7
    s_add_u32 s76, s76, s78
    s_lshl_b32 s73, s73, 16
    s_add_u32 s73, s73, s79
    s_add_u32 m0, s74, 131072
    s_nop 0
    buffer_load_dwordx4 v114, s[56:59], s76 offen lds
    v_mfma_f32_32x32x16_bf16 v[32:47], v[88:91], v[76:79], v[32:47]
    s_add_u32 m0, s74, 132096
    s_nop 0
    buffer_load_dwordx4 v115, s[56:59], s76 offen lds
    v_mfma_f32_32x32x16_bf16 v[16:31], v[92:95], v[72:75], v[16:31]
    s_add_u32 s77, s73, 0
    s_add_u32 m0, s75, 131072
    s_nop 0
    buffer_load_dwordx4 v116, s[44:47], s77 offen lds
    v_mfma_f32_32x32x16_bf16 v[48:63], v[92:95], v[76:79], v[48:63]
    s_add_u32 s77, s73, 4096
    s_add_u32 m0, s75, 132096
    s_nop 0
    buffer_load_dwordx4 v116, s[44:47], s77 offen lds
    ds_read_b128 v[72:75], v98 offset:0
    ds_read_b128 v[76:79], v99 offset:0
    ds_read_b64_tr_b16 v[88:89], v108 offset:4096
    ds_read_b64_tr_b16 v[90:91], v108 offset:5120
    ds_read_b64_tr_b16 v[92:93], v109 offset:4096
    ds_read_b64_tr_b16 v[94:95], v109 offset:5120
    s_waitcnt lgkmcnt(8)
    v_mfma_f32_32x32x16_bf16 v[0:15], v[80:83], v[64:67], v[0:15]
    v_mfma_f32_32x32x16_bf16 v[32:47], v[80:83], v[68:71], v[32:47]
    s_waitcnt lgkmcnt(6)
    v_mfma_f32_32x32x16_bf16 v[16:31], v[84:87], v[64:67], v[16:31]
    v_mfma_f32_32x32x16_bf16 v[48:63], v[84:87], v[68:71], v[48:63]
    s_waitcnt lgkmcnt(0)
    s_waitcnt vmcnt(12)
    s_barrier
    ds_read_b128 v[64:67], v96 offset:32768
    ds_read_b128 v[68:71], v97 offset:32768
    ds_read_b64_tr_b16 v[80:81], v108 offset:32768
    ds_read_b64_tr_b16 v[82:83], v108 offset:33792
    ds_read_b64_tr_b16 v[84:85], v109 offset:32768
    ds_read_b64_tr_b16 v[86:87], v109 offset:33792
    v_mfma_f32_32x32x16_bf16 v[0:15], v[88:91], v[72:75], v[0:15]
    s_add_u32 s73, s64, 10
    s_and_b32 s73, s73, 15
    s_lshl_b32 s76, s73, 7
    s_add_u32 s76, s76, s78
    s_lshl_b32 s73, s73, 16
    s_add_u32 s73, s73, s79
    s_add_u32 m0, s74, 0
    s_nop 0
    buffer_load_dwordx4 v114, s[56:59], s76 offen lds
    v_mfma_f32_32x32x16_bf16 v[32:47], v[88:91], v[76:79], v[32:47]
    s_add_u32 m0, s74, 1024
    s_nop 0
    buffer_load_dwordx4 v115, s[56:59], s76 offen lds
    v_mfma_f32_32x32x16_bf16 v[16:31], v[92:95], v[72:75], v[16:31]
    s_add_u32 s77, s73, 0
    s_add_u32 m0, s75, 0
    s_nop 0
    buffer_load_dwordx4 v116, s[44:47], s77 offen lds
    v_mfma_f32_32x32x16_bf16 v[48:63], v[92:95], v[76:79], v[48:63]
    s_add_u32 s77, s73, 4096
    s_add_u32 m0, s75, 1024
    s_nop 0
    buffer_load_dwordx4 v116, s[44:47], s77 offen lds
    ds_read_b128 v[72:75], v98 offset:32768
    ds_read_b128 v[76:79], v99 offset:32768
    ds_read_b64_tr_b16 v[88:89], v108 offset:36864
    ds_read_b64_tr_b16 v[90:91], v108 offset:37888
    ds_read_b64_tr_b16 v[92:93], v109 offset:36864
    ds_read_b64_tr_b16 v[94:95], v109 offset:37888
    s_waitcnt lgkmcnt(8)
    v_mfma_f32_32x32x16_bf16 v[0:15], v[80:83], v[64:67], v[0:15]
    v_mfma_f32_32x32x16_bf16 v[32:47], v[80:83], v[68:71], v[32:47]
    s_waitcnt lgkmcnt(6)
    v_mfma_f32_32x32x16_bf16 v[16:31], v[84:87], v[64:67], v[16:31]
    v_mfma_f32_32x32x16_bf16 v[48:63], v[84:87], v[68:71], v[48:63]
    s_waitcnt lgkmcnt(0)
    s_waitcnt vmcnt(12)
    s_barrier
    ds_read_b128 v[64:67], v100 offset:0
    ds_read_b128 v[68:71], v101 offset:0
    ds_read_b64_tr_b16 v[80:81], v110 offset:0
    ds_read_b64_tr_b16 v[82:83], v110 offset:1024
    ds_read_b64_tr_b16 v[84:85], v111 offset:0
    ds_read_b64_tr_b16 v[86:87], v111 offset:1024
    v_mfma_f32_32x32x16_bf16 v[0:15], v[88:91], v[72:75], v[0:15]
    s_add_u32 s73, s64, 11
    s_and_b32 s73, s73, 15
    s_lshl_b32 s76, s73, 7
    s_add_u32 s76, s76, s78
    s_lshl_b32 s73, s73, 16
    s_add_u32 s73, s73, s79
    s_add_u32 m0, s74, 32768
    s_nop 0
    buffer_load_dwordx4 v114, s[56:59], s76 offen lds
    v_mfma_f32_32x32x16_bf16 v[32:47], v[88:91], v[76:79], v[32:47]
    s_add_u32 m0, s74, 33792
    s_nop 0
    buffer_load_dwordx4 v115, s[56:59], s76 offen lds
    v_mfma_f32_32x32x16_bf16 v[16:31], v[92:95], v[72:75], v[16:31]
    s_add_u32 s77, s73, 0
    s_add_u32 m0, s75, 32768
    s_nop 0
    buffer_load_dwordx4 v116, s[44:47], s77 offen lds
    v_mfma_f32_32x32x16_bf16 v[48:63], v[92:95], v[76:79], v[48:63]
    s_add_u32 s77, s73, 4096
    s_add_u32 m0, s75, 33792
    s_nop 0
    buffer_load_dwordx4 v116, s[44:47], s77 offen lds
    ds_read_b128 v[72:75], v102 offset:0
    ds_read_b128 v[76:79], v103 offset:0
    ds_read_b64_tr_b16 v[88:89], v110 offset:4096
    ds_read_b64_tr_b16 v[90:91], v110 offset:5120
    ds_read_b64_tr_b16 v[92:93], v111 offset:4096
    ds_read_b64_tr_b16 v[94:95], v111 offset:5120
    s_waitcnt lgkmcnt(8)
    v_mfma_f32_32x32x16_bf16 v[0:15], v[80:83], v[64:67], v[0:15]
    v_mfma_f32_32x32x16_bf16 v[32:47], v[80:83], v[68:71], v[32:47]
    s_waitcnt lgkmcnt(6)
    v_mfma_f32_32x32x16_bf16 v[16:31], v[84:87], v[64:67], v[16:31]
    v_mfma_f32_32x32x16_bf16 v[48:63], v[84:87], v[68:71], v[48:63]
    s_waitcnt lgkmcnt(0)
    s_waitcnt vmcnt(12)
    s_barrier
    ds_read_b128 v[64:67], v100 offset:32768
    ds_read_b128 v[68:71], v101 offset:32768
    ds_read_b64_tr_b16 v[80:81], v110 offset:32768
    ds_read_b64_tr_b16 v[82:83], v110 offset:33792
    ds_read_b64_tr_b16 v[84:85], v111 offset:32768
    ds_read_b64_tr_b16 v[86:87], v111 offset:33792
    v_mfma_f32_32x32x16_bf16 v[0:15], v[88:91], v[72:75], v[0:15]
    s_add_u32 s73, s64, 12
    s_and_b32 s73, s73, 15
    s_lshl_b32 s76, s73, 7
    s_add_u32 s76, s76, s78
    s_lshl_b32 s73, s73, 16
    s_add_u32 s73, s73, s79
    s_add_u32 m0, s74, 65536
    s_nop 0
    buffer_load_dwordx4 v114, s[56:59], s76 offen lds
    v_mfma_f32_32x32x16_bf16 v[32:47], v[88:91], v[76:79], v[32:47]
    s_add_u32 m0, s74, 66560
    s_nop 0
    buffer_load_dwordx4 v115, s[56:59], s76 offen lds
    v_mfma_f32_32x32x16_bf16 v[16:31], v[92:95], v[72:75], v[16:31]
    s_add_u32 s77, s73, 0
    s_add_u32 m0, s75, 65536
    s_nop 0
    buffer_load_dwordx4 v116, s[44:47], s77 offen lds
    v_mfma_f32_32x32x16_bf16 v[48:63], v[92:95], v[76:79], v[48:63]
    s_add_u32 s77, s73, 4096
    s_add_u32 m0, s75, 66560
    s_nop 0
    buffer_load_dwordx4 v116, s[44:47], s77 offen lds
    ds_read_b128 v[72:75], v102 offset:32768
    ds_read_b128 v[76:79], v103 offset:32768
    ds_read_b64_tr_b16 v[88:89], v110 offset:36864
    ds_read_b64_tr_b16 v[90:91], v110 offset:37888
    ds_read_b64_tr_b16 v[92:93], v111 offset:36864
    ds_read_b64_tr_b16 v[94:95], v111 offset:37888
    s_waitcnt lgkmcnt(8)
    v_mfma_f32_32x32x16_bf16 v[0:15], v[80:83], v[64:67], v[0:15]
    v_mfma_f32_32x32x16_bf16 v[32:47], v[80:83], v[68:71], v[32:47]
    s_waitcnt lgkmcnt(6)
    v_mfma_f32_32x32x16_bf16 v[16:31], v[84:87], v[64:67], v[16:31]
    v_mfma_f32_32x32x16_bf16 v[48:63], v[84:87], v[68:71], v[48:63]
    s_waitcnt lgkmcnt(0)
    s_waitcnt vmcnt(12)
    s_barrier
    ds_read_b128 v[64:67], v104 offset:0
    ds_read_b128 v[68:71], v105 offset:0
    ds_read_b64_tr_b16 v[80:81], v112 offset:0
    ds_read_b64_tr_b16 v[82:83], v112 offset:1024
    ds_read_b64_tr_b16 v[84:85], v113 offset:0
    ds_read_b64_tr_b16 v[86:87], v113 offset:1024
    v_mfma_f32_32x32x16_bf16 v[0:15], v[88:91], v[72:75], v[0:15]
    s_add_u32 s73, s64, 13
    s_and_b32 s73, s73, 15
    s_lshl_b32 s76, s73, 7
    s_add_u32 s76, s76, s78
    s_lshl_b32 s73, s73, 16
    s_add_u32 s73, s73, s79
    s_add_u32 m0, s74, 98304
    s_nop 0
    buffer_load_dwordx4 v114, s[56:59], s76 offen lds
    v_mfma_f32_32x32x16_bf16 v[32:47], v[88:91], v[76:79], v[32:47]
    s_add_u32 m0, s74, 99328
    s_nop 0
    buffer_load_dwordx4 v115, s[56:59], s76 offen lds
    v_mfma_f32_32x32x16_bf16 v[16:31], v[92:95], v[72:75], v[16:31]
    s_add_u32 s77, s73, 0
    s_add_u32 m0, s75, 98304
    s_nop 0
    buffer_load_dwordx4 v116, s[44:47], s77 offen lds
    v_mfma_f32_32x32x16_bf16 v[48:63], v[92:95], v[76:79], v[48:63]
    s_add_u32 s77, s73, 4096
    s_add_u32 m0, s75, 99328
    s_nop 0
    buffer_load_dwordx4 v116, s[44:47], s77 offen lds
    ds_read_b128 v[72:75], v106 offset:0
    ds_read_b128 v[76:79], v107 offset:0
    ds_read_b64_tr_b16 v[88:89], v112 offset:4096
    ds_read_b64_tr_b16 v[90:91], v112 offset:5120
    ds_read_b64_tr_b16 v[92:93], v113 offset:4096
    ds_read_b64_tr_b16 v[94:95], v113 offset:5120
    s_waitcnt lgkmcnt(8)
    v_mfma_f32_32x32x16_bf16 v[0:15], v[80:83], v[64:67], v[0:15]
    v_mfma_f32_32x32x16_bf16 v[32:47], v[80:83], v[68:71], v[32:47]
    s_waitcnt lgkmcnt(6)
    v_mfma_f32_32x32x16_bf16 v[16:31], v[84:87], v[64:67], v[16:31]
    v_mfma_f32_32x32x16_bf16 v[48:63], v[84:87], v[68:71], v[48:63]
    s_waitcnt lgkmcnt(0)
    s_waitcnt vmcnt(12)
    s_barrier
    ds_read_b128 v[64:67], v96 offset:0
    ds_read_b128 v[68:71], v97 offset:0
    ds_read_b64_tr_b16 v[80:81], v108 offset:0
    ds_read_b64_tr_b16 v[82:83], v108 offset:1024
    ds_read_b64_tr_b16 v[84:85], v109 offset:0
    ds_read_b64_tr_b16 v[86:87], v109 offset:1024
    v_mfma_f32_32x32x16_bf16 v[0:15], v[88:91], v[72:75], v[0:15]
    s_add_u32 s73, s64, 14
    s_and_b32 s73, s73, 15
    s_lshl_b32 s76, s73, 7
    s_add_u32 s76, s76, s78
    s_lshl_b32 s73, s73, 16
    s_add_u32 s73, s73, s79
    s_add_u32 m0, s74, 131072
    s_nop 0
    buffer_load_dwordx4 v114, s[56:59], s76 offen lds
    v_mfma_f32_32x32x16_bf16 v[32:47], v[88:91], v[76:79], v[32:47]
    s_add_u32 m0, s74, 132096
    s_nop 0
    buffer_load_dwordx4 v115, s[56:59], s76 offen lds
    v_mfma_f32_32x32x16_bf16 v[16:31], v[92:95], v[72:75], v[16:31]
    s_add_u32 s77, s73, 0
    s_add_u32 m0, s75, 131072
    s_nop 0
    buffer_load_dwordx4 v116, s[44:47], s77 offen lds
    v_mfma_f32_32x32x16_bf16 v[48:63], v[92:95], v[76:79], v[48:63]
    s_add_u32 s77, s73, 4096
    s_add_u32 m0, s75, 132096
    s_nop 0
    buffer_load_dwordx4 v116, s[44:47], s77 offen lds
    ds_read_b128 v[72:75], v98 offset:0
    ds_read_b128 v[76:79], v99 offset:0
    ds_read_b64_tr_b16 v[88:89], v108 offset:4096
    ds_read_b64_tr_b16 v[90:91], v108 offset:5120
    ds_read_b64_tr_b16 v[92:93], v109 offset:4096
    ds_read_b64_tr_b16 v[94:95], v109 offset:5120
    s_waitcnt lgkmcnt(8)
    v_mfma_f32_32x32x16_bf16 v[0:15], v[80:83], v[64:67], v[0:15]
    v_mfma_f32_32x32x16_bf16 v[32:47], v[80:83], v[68:71], v[32:47]
    s_waitcnt lgkmcnt(6)
    v_mfma_f32_32x32x16_bf16 v[16:31], v[84:87], v[64:67], v[16:31]
    v_mfma_f32_32x32x16_bf16 v[48:63], v[84:87], v[68:71], v[48:63]
    s_waitcnt lgkmcnt(0)
    s_waitcnt vmcnt(12)
    s_barrier
    ds_read_b128 v[64:67], v96 offset:32768
    ds_read_b128 v[68:71], v97 offset:32768
    ds_read_b64_tr_b16 v[80:81], v108 offset:32768
    ds_read_b64_tr_b16 v[82:83], v108 offset:33792
    ds_read_b64_tr_b16 v[84:85], v109 offset:32768
    ds_read_b64_tr_b16 v[86:87], v109 offset:33792
    v_mfma_f32_32x32x16_bf16 v[0:15], v[88:91], v[72:75], v[0:15]
    s_add_u32 s73, s64, 15
    s_and_b32 s73, s73, 15
    s_lshl_b32 s76, s73, 7
    s_add_u32 s76, s76, s78
    s_lshl_b32 s73, s73, 16
    s_add_u32 s73, s73, s79
    s_add_u32 m0, s74, 0
    s_nop 0
    buffer_load_dwordx4 v114, s[56:59], s76 offen lds
    v_mfma_f32_32x32x16_bf16 v[32:47], v[88:91], v[76:79], v[32:47]
    s_add_u32 m0, s74, 1024
    s_nop 0
    buffer_load_dwordx4 v115, s[56:59], s76 offen lds
    v_mfma_f32_32x32x16_bf16 v[16:31], v[92:95], v[72:75], v[16:31]
    s_add_u32 s77, s73, 0
    s_add_u32 m0, s75, 0
    s_nop 0
    buffer_load_dwordx4 v116, s[44:47], s77 offen lds
    v_mfma_f32_32x32x16_bf16 v[48:63], v[92:95], v[76:79], v[48:63]
    s_add_u32 s77, s73, 4096
    s_add_u32 m0, s75, 1024
    s_nop 0
    buffer_load_dwordx4 v116, s[44:47], s77 offen lds
    ds_read_b128 v[72:75], v98 offset:32768
    ds_read_b128 v[76:79], v99 offset:32768
    ds_read_b64_tr_b16 v[88:89], v108 offset:36864
    ds_read_b64_tr_b16 v[90:91], v108 offset:37888
    ds_read_b64_tr_b16 v[92:93], v109 offset:36864
    ds_read_b64_tr_b16 v[94:95], v109 offset:37888
    s_waitcnt lgkmcnt(8)
    v_mfma_f32_32x32x16_bf16 v[0:15], v[80:83], v[64:67], v[0:15]
    v_mfma_f32_32x32x16_bf16 v[32:47], v[80:83], v[68:71], v[32:47]
    s_waitcnt lgkmcnt(6)
    v_mfma_f32_32x32x16_bf16 v[16:31], v[84:87], v[64:67], v[16:31]
    v_mfma_f32_32x32x16_bf16 v[48:63], v[84:87], v[68:71], v[48:63]
    s_waitcnt lgkmcnt(0)
    s_waitcnt vmcnt(12)
    s_barrier
    ds_read_b128 v[64:67], v100 offset:0
    ds_read_b128 v[68:71], v101 offset:0
    ds_read_b64_tr_b16 v[80:81], v110 offset:0
    ds_read_b64_tr_b16 v[82:83], v110 offset:1024
    ds_read_b64_tr_b16 v[84:85], v111 offset:0
    ds_read_b64_tr_b16 v[86:87], v111 offset:1024
    v_mfma_f32_32x32x16_bf16 v[0:15], v[88:91], v[72:75], v[0:15]
    v_mfma_f32_32x32x16_bf16 v[32:47], v[88:91], v[76:79], v[32:47]
    v_mfma_f32_32x32x16_bf16 v[16:31], v[92:95], v[72:75], v[16:31]
    v_mfma_f32_32x32x16_bf16 v[48:63], v[92:95], v[76:79], v[48:63]
    ds_read_b128 v[72:75], v102 offset:0
    ds_read_b128 v[76:79], v103 offset:0
    ds_read_b64_tr_b16 v[88:89], v110 offset:4096
    ds_read_b64_tr_b16 v[90:91], v110 offset:5120
    ds_read_b64_tr_b16 v[92:93], v111 offset:4096
    ds_read_b64_tr_b16 v[94:95], v111 offset:5120
    s_waitcnt lgkmcnt(8)
    v_mfma_f32_32x32x16_bf16 v[0:15], v[80:83], v[64:67], v[0:15]
    v_mfma_f32_32x32x16_bf16 v[32:47], v[80:83], v[68:71], v[32:47]
    s_waitcnt lgkmcnt(6)
    v_mfma_f32_32x32x16_bf16 v[16:31], v[84:87], v[64:67], v[16:31]
    v_mfma_f32_32x32x16_bf16 v[48:63], v[84:87], v[68:71], v[48:63]
    s_waitcnt lgkmcnt(0)
    s_waitcnt vmcnt(8)
    s_barrier
    ds_read_b128 v[64:67], v100 offset:32768
    ds_read_b128 v[68:71], v101 offset:32768
    ds_read_b64_tr_b16 v[80:81], v110 offset:32768
    ds_read_b64_tr_b16 v[82:83], v110 offset:33792
    ds_read_b64_tr_b16 v[84:85], v111 offset:32768
    ds_read_b64_tr_b16 v[86:87], v111 offset:33792
    v_mfma_f32_32x32x16_bf16 v[0:15], v[88:91], v[72:75], v[0:15]
    v_mfma_f32_32x32x16_bf16 v[32:47], v[88:91], v[76:79], v[32:47]
    v_mfma_f32_32x32x16_bf16 v[16:31], v[92:95], v[72:75], v[16:31]
    v_mfma_f32_32x32x16_bf16 v[48:63], v[92:95], v[76:79], v[48:63]
    ds_read_b128 v[72:75], v102 offset:32768
    ds_read_b128 v[76:79], v103 offset:32768
    ds_read_b64_tr_b16 v[88:89], v110 offset:36864
    ds_read_b64_tr_b16 v[90:91], v110 offset:37888
    ds_read_b64_tr_b16 v[92:93], v111 offset:36864
    ds_read_b64_tr_b16 v[94:95], v111 offset:37888
    s_waitcnt lgkmcnt(8)
    v_mfma_f32_32x32x16_bf16 v[0:15], v[80:83], v[64:67], v[0:15]
    v_mfma_f32_32x32x16_bf16 v[32:47], v[80:83], v[68:71], v[32:47]
    s_waitcnt lgkmcnt(6)
    v_mfma_f32_32x32x16_bf16 v[16:31], v[84:87], v[64:67], v[16:31]
    v_mfma_f32_32x32x16_bf16 v[48:63], v[84:87], v[68:71], v[48:63]
    s_waitcnt lgkmcnt(0)
    s_waitcnt vmcnt(4)
    s_barrier
    ds_read_b128 v[64:67], v104 offset:0
    ds_read_b128 v[68:71], v105 offset:0
    ds_read_b64_tr_b16 v[80:81], v112 offset:0
    ds_read_b64_tr_b16 v[82:83], v112 offset:1024
    ds_read_b64_tr_b16 v[84:85], v113 offset:0
    ds_read_b64_tr_b16 v[86:87], v113 offset:1024
    v_mfma_f32_32x32x16_bf16 v[0:15], v[88:91], v[72:75], v[0:15]
    v_mfma_f32_32x32x16_bf16 v[32:47], v[88:91], v[76:79], v[32:47]
    v_mfma_f32_32x32x16_bf16 v[16:31], v[92:95], v[72:75], v[16:31]
    v_mfma_f32_32x32x16_bf16 v[48:63], v[92:95], v[76:79], v[48:63]
    ds_read_b128 v[72:75], v106 offset:0
    ds_read_b128 v[76:79], v107 offset:0
    ds_read_b64_tr_b16 v[88:89], v112 offset:4096
    ds_read_b64_tr_b16 v[90:91], v112 offset:5120
    ds_read_b64_tr_b16 v[92:93], v113 offset:4096
    ds_read_b64_tr_b16 v[94:95], v113 offset:5120
    s_waitcnt lgkmcnt(8)
    v_mfma_f32_32x32x16_bf16 v[0:15], v[80:83], v[64:67], v[0:15]
    v_mfma_f32_32x32x16_bf16 v[32:47], v[80:83], v[68:71], v[32:47]
    s_waitcnt lgkmcnt(6)
    v_mfma_f32_32x32x16_bf16 v[16:31], v[84:87], v[64:67], v[16:31]
    v_mfma_f32_32x32x16_bf16 v[48:63], v[84:87], v[68:71], v[48:63]
    s_waitcnt lgkmcnt(0)
    s_waitcnt vmcnt(0)
    s_barrier
    ds_read_b128 v[64:67], v96 offset:0
    ds_read_b128 v[68:71], v97 offset:0
    ds_read_b64_tr_b16 v[80:81], v108 offset:0
    ds_read_b64_tr_b16 v[82:83], v108 offset:1024
    ds_read_b64_tr_b16 v[84:85], v109 offset:0
    ds_read_b64_tr_b16 v[86:87], v109 offset:1024
    v_mfma_f32_32x32x16_bf16 v[0:15], v[88:91], v[72:75], v[0:15]
    v_mfma_f32_32x32x16_bf16 v[32:47], v[88:91], v[76:79], v[32:47]
    v_mfma_f32_32x32x16_bf16 v[16:31], v[92:95], v[72:75], v[16:31]
    v_mfma_f32_32x32x16_bf16 v[48:63], v[92:95], v[76:79], v[48:63]
    ds_read_b128 v[72:75], v98 offset:0
    ds_read_b128 v[76:79], v99 offset:0
    ds_read_b64_tr_b16 v[88:89], v108 offset:4096
    ds_read_b64_tr_b16 v[90:91], v108 offset:5120
    ds_read_b64_tr_b16 v[92:93], v109 offset:4096
    ds_read_b64_tr_b16 v[94:95], v109 offset:5120
    s_waitcnt lgkmcnt(8)
    v_mfma_f32_32x32x16_bf16 v[0:15], v[80:83], v[64:67], v[0:15]
    v_mfma_f32_32x32x16_bf16 v[32:47], v[80:83], v[68:71], v[32:47]
    s_waitcnt lgkmcnt(6)
    v_mfma_f32_32x32x16_bf16 v[16:31], v[84:87], v[64:67], v[16:31]
    v_mfma_f32_32x32x16_bf16 v[48:63], v[84:87], v[68:71], v[48:63]
    s_waitcnt lgkmcnt(0)
    v_mfma_f32_32x32x16_bf16 v[0:15], v[88:91], v[72:75], v[0:15]
    v_mfma_f32_32x32x16_bf16 v[32:47], v[88:91], v[76:79], v[32:47]
    v_mfma_f32_32x32x16_bf16 v[16:31], v[92:95], v[72:75], v[16:31]
    v_mfma_f32_32x32x16_bf16 v[48:63], v[92:95], v[76:79], v[48:63]
    s_barrier
    v_and_b32 v190, 31, v200
    v_lshrrev_b32 v191, 5, v200
    s_lshl_b32 s70, s62, 6
    v_add_u32 v190, s70, v190
    s_movk_i32 s71, 528
    v_mul_lo_u32 v190, v190, s71
    v_lshl_add_u32 v190, v191, 5, v190
    s_mul_i32 s70, s61, 67584
    s_lshl_b32 s71, s65, 8
    s_add_u32 s70, s70, s71
    v_add_u32 v190, s70, v190
    s_nop 3
    ds_write_b128 v190, v[0:3] offset:0
    ds_write_b128 v190, v[4:7] offset:16
    ds_write_b128 v190, v[8:11] offset:64
    ds_write_b128 v190, v[12:15] offset:80
    ds_write_b128 v190, v[16:19] offset:128
    ds_write_b128 v190, v[20:23] offset:144
    ds_write_b128 v190, v[24:27] offset:192
    ds_write_b128 v190, v[28:31] offset:208
    s_waitcnt lgkmcnt(4)
    ds_write_b128 v190, v[32:35] offset:16896
    ds_write_b128 v190, v[36:39] offset:16912
    ds_write_b128 v190, v[40:43] offset:16960
    ds_write_b128 v190, v[44:47] offset:16976
    ds_write_b128 v190, v[48:51] offset:17024
    ds_write_b128 v190, v[52:55] offset:17040
    ds_write_b128 v190, v[56:59] offset:17088
    ds_write_b128 v190, v[60:63] offset:17104
    s_waitcnt lgkmcnt(4)
    s_waitcnt lgkmcnt(0)
    s_barrier
    v_lshrrev_b32 v191, 5, v200
    v_and_b32 v192, 31, v200
    s_lshl_b32 s70, s60, 4
    v_add_u32 v193, s70, v191
    s_movk_i32 s71, 528
    v_mul_lo_u32 v193, v193, s71
    v_lshl_add_u32 v193, v192, 4, v193
    v_add_u32 v194, 0x10800, v193
    v_lshlrev_b32 v191, 10, v191
    v_lshl_add_u32 v191, v192, 3, v191
    s_lshl_b32 s66, s63, 7
    s_lshl_b32 s66, s66, 10
    s_lshl_b32 s71, s39, 8
    s_add_u32 s66, s66, s71
    s_lshr_b32 s71, s60, 1
    s_cmp_eq_u32 s71, s81
    s_cbranch_scc1 F_P_SKIP
    ds_read_b128 v[0:3], v193 offset:0
    ds_read_b128 v[32:35], v194 offset:0
    ds_read_b128 v[4:7], v193 offset:1056
    ds_read_b128 v[36:39], v194 offset:1056
    ds_read_b128 v[8:11], v193 offset:2112
    ds_read_b128 v[40:43], v194 offset:2112
    ds_read_b128 v[12:15], v193 offset:3168
    ds_read_b128 v[44:47], v194 offset:3168
    ds_read_b128 v[16:19], v193 offset:4224
    ds_read_b128 v[48:51], v194 offset:4224
    ds_read_b128 v[20:23], v193 offset:5280
    ds_read_b128 v[52:55], v194 offset:5280
    s_lshl_b32 s70, s70, 10
    s_add_u32 s70, s70, s66
    s_lshl_b32 s71, s81, 20
    s_add_u32 s70, s70, s71
    s_waitcnt lgkmcnt(10)
    ds_read_b128 v[24:27], v193 offset:6336
    ds_read_b128 v[56:59], v194 offset:6336
    v_add_f32 v0, v0, v32
    v_add_f32 v1, v1, v33
    v_add_f32 v2, v2, v34
    v_add_f32 v3, v3, v35
    s_add_u32 s71, s70, 0
    v_cvt_pk_bf16_f32 v0, v0, v1
    v_cvt_pk_bf16_f32 v1, v2, v3
    buffer_store_dwordx2 v[0:1], v191, s[52:55], s71 offen sc1
    s_waitcnt lgkmcnt(10)
    ds_read_b128 v[28:31], v193 offset:7392
    ds_read_b128 v[60:63], v194 offset:7392
    v_add_f32 v4, v4, v36
    v_add_f32 v5, v5, v37
    v_add_f32 v6, v6, v38
    v_add_f32 v7, v7, v39
    s_add_u32 s71, s70, 2048
    v_cvt_pk_bf16_f32 v4, v4, v5
    v_cvt_pk_bf16_f32 v5, v6, v7
    buffer_store_dwordx2 v[4:5], v191, s[52:55], s71 offen sc1
    s_waitcnt lgkmcnt(10)
    v_add_f32 v8, v8, v40
    v_add_f32 v9, v9, v41
    v_add_f32 v10, v10, v42
    v_add_f32 v11, v11, v43
    s_add_u32 s71, s70, 4096
    v_cvt_pk_bf16_f32 v8, v8, v9
    v_cvt_pk_bf16_f32 v9, v10, v11
    buffer_store_dwordx2 v[8:9], v191, s[52:55], s71 offen sc1
    s_waitcnt lgkmcnt(8)
    v_add_f32 v12, v12, v44
    v_add_f32 v13, v13, v45
    v_add_f32 v14, v14, v46
    v_add_f32 v15, v15, v47
    s_add_u32 s71, s70, 6144
    v_cvt_pk_bf16_f32 v12, v12, v13
    v_cvt_pk_bf16_f32 v13, v14, v15
    buffer_store_dwordx2 v[12:13], v191, s[52:55], s71 offen sc1
    s_waitcnt lgkmcnt(6)
    v_add_f32 v16, v16, v48
    v_add_f32 v17, v17, v49
    v_add_f32 v18, v18, v50
    v_add_f32 v19, v19, v51
    s_add_u32 s71, s70, 8192
    v_cvt_pk_bf16_f32 v16, v16, v17
    v_cvt_pk_bf16_f32 v17, v18, v19
    buffer_store_dwordx2 v[16:17], v191, s[52:55], s71 offen sc1
    s_waitcnt lgkmcnt(4)
    v_add_f32 v20, v20, v52
    v_add_f32 v21, v21, v53
    v_add_f32 v22, v22, v54
    v_add_f32 v23, v23, v55
    s_add_u32 s71, s70, 10240
    v_cvt_pk_bf16_f32 v20, v20, v21
    v_cvt_pk_bf16_f32 v21, v22, v23
    buffer_store_dwordx2 v[20:21], v191, s[52:55], s71 offen sc1
    s_waitcnt lgkmcnt(2)
    v_add_f32 v24, v24, v56
    v_add_f32 v25, v25, v57
    v_add_f32 v26, v26, v58
    v_add_f32 v27, v27, v59
    s_add_u32 s71, s70, 12288
    v_cvt_pk_bf16_f32 v24, v24, v25
    v_cvt_pk_bf16_f32 v25, v26, v27
    buffer_store_dwordx2 v[24:25], v191, s[52:55], s71 offen sc1
    s_waitcnt lgkmcnt(0)
    v_add_f32 v28, v28, v60
    v_add_f32 v29, v29, v61
    v_add_f32 v30, v30, v62
    v_add_f32 v31, v31, v63
    s_add_u32 s71, s70, 14336
    v_cvt_pk_bf16_f32 v28, v28, v29
    v_cvt_pk_bf16_f32 v29, v30, v31
    buffer_store_dwordx2 v[28:29], v191, s[52:55], s71 offen sc1
F_P_SKIP:
    s_waitcnt vmcnt(0)
    s_barrier
    s_cmp_lg_u32 s60, 0
    s_cbranch_scc1 F_S2_DONE
    s_lshl_b32 s67, s80, 5
    s_lshl_b32 s70, s63, 2
    s_add_u32 s67, s67, s70
    s_add_u32 s67, s67, s39
    s_add_u32 s67, s67, 64
    s_lshl_b32 s67, s67, 7
    s_lshl_b32 s70, s81, 3
    s_add_u32 s70, s70, s67
    v_mov_b32 v190, s70
    v_mov_b32 v192, s68
    v_mov_b32 v193, s12
    v_cmp_eq_u32 vcc, 0, v200
    s_and_saveexec_b64 s[10:11], vcc
    buffer_store_dwordx2 v[192:193], v190, s[48:51], 0 offen sc0 sc1
    s_mov_b64 exec, s[10:11]
    v_and_b32 v190, 3, v200
    v_lshlrev_b32 v190, 3, v190
    v_add_u32 v190, s67, v190
    s_mov_b32 s69, 0
F_S2A_POLL:
    buffer_load_dwordx2 v[192:193], v190, s[48:51], 0 offen offset:0 sc0 sc1
    s_waitcnt vmcnt(0)
    v_cmp_ne_u32 vcc, s68, v192
    s_nop 3
    s_cmp_eq_u64 vcc, 0
    s_cbranch_scc1 F_S2A_OK
    s_sleep 2
    s_add_u32 s69, s69, 1
    s_cmp_lt_u32 s69, 200000
    s_cbranch_scc1 F_S2A_POLL
F_S2A_OK:
F_S2_DONE:
    s_barrier
    s_mov_b32 s40, s26
    s_and_b32 s41, s27, 0xffff
    s_mov_b32 s42, 0x200000
    s_mov_b32 s43, 0x00020000
    s_lshl_b32 s70, s81, 5
    s_lshl_b32 s71, s60, 2
    s_add_u32 s70, s70, s71
    v_lshrrev_b32 v192, 5, v200
    v_and_b32 v193, 31, v200
    v_add_u32 v194, s70, v192
    s_movk_i32 s71, 528
    v_mul_lo_u32 v194, v194, s71
    v_lshl_add_u32 v194, v193, 4, v194
    v_add_u32 v190, 0x10800, v194
    s_lshl_b32 s71, s70, 10
    s_add_u32 s71, s71, s66
    s_add_u32 s72, s81, 1
    s_and_b32 s72, s72, 3
    s_lshl_b32 s72, s72, 20
    s_add_u32 s72, s72, s71
    s_add_u32 s73, s72, 2048
    buffer_load_dwordx2 v[44:45], v191, s[52:55], s72 offen sc1
    buffer_load_dwordx2 v[46:47], v191, s[52:55], s73 offen sc1
    s_add_u32 s72, s81, 2
    s_and_b32 s72, s72, 3
    s_lshl_b32 s72, s72, 20
    s_add_u32 s72, s72, s71
    s_add_u32 s73, s72, 2048
    buffer_load_dwordx2 v[48:49], v191, s[52:55], s72 offen sc1
    buffer_load_dwordx2 v[50:51], v191, s[52:55], s73 offen sc1
    s_add_u32 s72, s81, 3
    s_and_b32 s72, s72, 3
    s_lshl_b32 s72, s72, 20
    s_add_u32 s72, s72, s71
    s_add_u32 s73, s72, 2048
    buffer_load_dwordx2 v[52:53], v191, s[52:55], s72 offen sc1
    buffer_load_dwordx2 v[54:55], v191, s[52:55], s73 offen sc1
    ds_read_b128 v[0:3], v194 offset:0
    ds_read_b128 v[8:11], v190 offset:0
    ds_read_b128 v[4:7], v194 offset:1056
    ds_read_b128 v[12:15], v190 offset:1056
    v_lshlrev_b32 v192, 11, v192
    v_lshl_add_u32 v192, v193, 3, v192
    s_lshl_b32 s71, s63, 7
    s_add_u32 s71, s71, s70
    s_lshl_b32 s71, s71, 11
    s_lshl_b32 s72, s80, 10
    s_add_u32 s71, s71, s72
    s_lshl_b32 s72, s39, 8
    s_add_u32 s71, s71, s72
    s_add_u32 s72, s71, 4096
    s_waitcnt lgkmcnt(0)
    v_add_f32 v0, v0, v8
    v_add_f32 v1, v1, v9
    v_add_f32 v2, v2, v10
    v_add_f32 v3, v3, v11
    v_add_f32 v4, v4, v12
    v_add_f32 v5, v5, v13
    v_add_f32 v6, v6, v14
    v_add_f32 v7, v7, v15
    s_waitcnt vmcnt(0)
    v_lshlrev_b32 v16, 16, v44
    v_and_b32 v17, 0xffff0000, v44
    v_lshlrev_b32 v18, 16, v45
    v_and_b32 v19, 0xffff0000, v45
    v_lshlrev_b32 v20, 16, v46
    v_and_b32 v21, 0xffff0000, v46
    v_lshlrev_b32 v22, 16, v47
    v_and_b32 v23, 0xffff0000, v47
    v_lshlrev_b32 v24, 16, v48
    v_and_b32 v25, 0xffff0000, v48
    v_lshlrev_b32 v26, 16, v49
    v_and_b32 v27, 0xffff0000, v49
    v_lshlrev_b32 v28, 16, v50
    v_and_b32 v29, 0xffff0000, v50
    v_lshlrev_b32 v30, 16, v51
    v_and_b32 v31, 0xffff0000, v51
    v_lshlrev_b32 v32, 16, v52
    v_and_b32 v33, 0xffff0000, v52
    v_lshlrev_b32 v34, 16, v53
    v_and_b32 v35, 0xffff0000, v53
    v_lshlrev_b32 v36, 16, v54
    v_and_b32 v37, 0xffff0000, v54
    v_lshlrev_b32 v38, 16, v55
    v_and_b32 v39, 0xffff0000, v55
    v_add_f32 v16, v16, v24
    v_add_f32 v0, v0, v32
    v_add_f32 v17, v17, v25
    v_add_f32 v1, v1, v33
    v_add_f32 v18, v18, v26
    v_add_f32 v2, v2, v34
    v_add_f32 v19, v19, v27
    v_add_f32 v3, v3, v35
    v_add_f32 v20, v20, v28
    v_add_f32 v4, v4, v36
    v_add_f32 v21, v21, v29
    v_add_f32 v5, v5, v37
    v_add_f32 v22, v22, v30
    v_add_f32 v6, v6, v38
    v_add_f32 v23, v23, v31
    v_add_f32 v7, v7, v39
    v_add_f32 v0, v0, v16
    v_add_f32 v1, v1, v17
    v_add_f32 v2, v2, v18
    v_add_f32 v3, v3, v19
    v_add_f32 v4, v4, v20
    v_add_f32 v5, v5, v21
    v_add_f32 v6, v6, v22
    v_add_f32 v7, v7, v23
    v_cvt_pk_bf16_f32 v40, v0, v1
    v_cvt_pk_bf16_f32 v41, v2, v3
    v_cvt_pk_bf16_f32 v42, v4, v5
    v_cvt_pk_bf16_f32 v43, v6, v7
    buffer_store_dwordx2 v[40:41], v192, s[40:43], s71 offen
    buffer_store_dwordx2 v[42:43], v192, s[40:43], s72 offen
F_DONE:
    s_endpgm
.section .rodata,"a"
.p2align 6
.amdhsa_kernel concat_heads__gqa_block_cached__mha_block_cached__near_ridge_kernel
  .amdhsa_next_free_vgpr 216
  .amdhsa_next_free_sgpr 100
  .amdhsa_accum_offset 216
  .amdhsa_group_segment_fixed_size 0
  .amdhsa_kernarg_size 104
  .amdhsa_user_sgpr_count 2
  .amdhsa_user_sgpr_kernarg_segment_ptr 1
  .amdhsa_system_sgpr_workgroup_id_x 1
.end_amdhsa_kernel
```
